```python
import torch

def _softmax(x, axis=-1):
    return torch.softmax(x, dim=axis)

def _gelu(x):
    return torch.nn.functional.gelu(x, approximate='tanh')

def _silu(x):
    return torch.nn.functional.silu(x)

def _sigmoid(x):
    return torch.sigmoid(x)

def _layernorm(x, axis=-1, eps=1e-05):
    m = x.mean(dim=axis, keepdim=True)
    v = x.var(dim=axis, keepdim=True, unbiased=False)
    return (x - m) / torch.sqrt(v + eps)

def _scatter_add(tgt, idx, src, axis=0):
    return tgt.clone().index_add_(axis, idx, src)

def _segment_sum(src, seg, n):
    out = torch.zeros((n,) + src.shape[1:], dtype=src.dtype)
    return out.index_add_(0, seg, src)

def _pad(x, pw):
    flat = tuple((v for pair in reversed(pw) for v in pair))
    return torch.nn.functional.pad(x, flat)
kernel_name = 'adaLN_cond__ssm_conv_s4d__moe_arch_mod__prompt'

def setup_inputs():

    _w = lambda a: (lambda t: t.to(torch.bfloat16) if t.is_floating_point() else t)(torch.as_tensor(a))

    def _A_setup():
        Bsz, L, D, N = (1, 2048, 512, 128)
        return {'u': _w((lambda *s: torch.randn(*s, dtype=torch.bfloat16) * 0.05)(Bsz, L, D)), 'log_A_real': _w((lambda *s: torch.randn(*s, dtype=torch.bfloat16) * 3.2)(D, N) * 0.5), 'A_imag': _w((lambda *s: torch.randn(*s, dtype=torch.bfloat16) * 0.1)(D, N) * 3.14), 'C_real': _w((lambda *s: torch.randn(*s, dtype=torch.bfloat16) * 0.4)(D, N) / N ** 0.5), 'C_imag': _w((lambda *s: torch.randn(*s, dtype=torch.bfloat16) * 0.4)(D, N) / N ** 0.5), 'log_dt': _w((lambda *s: torch.randn(*s, dtype=torch.bfloat16) * 0.1)(D) * 0.5 - 4.0), 'D_skip': _w((lambda *s: torch.randn(*s, dtype=torch.bfloat16) * 0.1)(D))}
    _A_in = _A_setup()

    def _B_setup():
        B, S, D, F, C = (1, 2048, 512, 1376, 2)
        return {'x': _w((lambda *s: torch.randn(*s, dtype=torch.bfloat16) * 0.05)(B, S, D)), 'w_r': _w((lambda *s: torch.randn(*s, dtype=torch.bfloat16) * 0.05)(D)), 'w_gate': _w((lambda *s: torch.randn(*s, dtype=torch.bfloat16) * 0.05)(D, F)), 'w_up': _w((lambda *s: torch.randn(*s, dtype=torch.bfloat16) * 0.05)(D, F)), 'w_down': _w((lambda *s: torch.randn(*s, dtype=torch.bfloat16) * 0.05)(F, D))}
    _B_in = _B_setup()
    return {'A_u': _A_in['u'], 'A_log_A_real': _A_in['log_A_real'], 'A_A_imag': _A_in['A_imag'], 'A_C_real': _A_in['C_real'], 'A_C_imag': _A_in['C_imag'], 'A_log_dt': _A_in['log_dt'], 'A_D_skip': _A_in['D_skip'], 'B_x': _B_in['x'], 'B_w_r': _B_in['w_r'], 'B_w_gate': _B_in['w_gate'], 'B_w_up': _B_in['w_up'], 'B_w_down': _B_in['w_down'], 'c': _w((lambda *s: torch.randn(*s, dtype=torch.bfloat16) * 0.1)(1, 512) * 8.0), 'w_mod': _w((lambda *s: torch.randn(*s, dtype=torch.bfloat16) * 0.1)(512, 6 * 512) * 512 ** (-0.5) * 8.0)}

def reference(A_u, A_log_A_real, A_A_imag, A_C_real, A_C_imag, A_log_dt, A_D_skip, B_x, B_w_r, B_w_gate, B_w_up, B_w_down, c, w_mod):

    def _A_ref(u, log_A_real, A_imag, C_real, C_imag, log_dt, D_skip):
        L = u.shape[1]
        dt = torch.exp(log_dt)
        A = -torch.exp(log_A_real) + 1j * A_imag
        C = (C_real + 1j * C_imag) * dt[:, None]
        pos = (lambda x, dt: x.to(dt))(torch.arange(L), log_dt.dtype)
        P = torch.exp((A * dt[:, None])[:, :, None] * pos[None, None, :])
        K = 2.0 * torch.einsum('dn,dnl->dl', C, P).real
        L2 = 2 * L
        u_t = (lambda x, *d: x.permute(*d))(u, 0, 2, 1)
        Kf = (lambda x, *a, **k: torch.fft.rfft(x.float(), *a, **k))(K, L2)
        Uf = (lambda x, *a, **k: torch.fft.rfft(x.float(), *a, **k))(u_t, L2)
        y = (lambda x, *a, **k: torch.fft.irfft(x, *a, **k).to(torch.bfloat16))(Uf * Kf[None, :, :], L2)[:, :, :L]
        y = (lambda x, *d: x.permute(*d))(y, 0, 2, 1)
        return y + u * D_skip[None, None, :]

    def _B_ref(x, w_r, w_gate, w_up, w_down):
        B, S, D = x.shape
        C = 2
        r = x @ w_r
        idx = torch.argsort(-r, axis=-1)[:, :C]
        idx_e = (lambda x, n, axis: torch.repeat_interleave(x, n, dim=axis))(idx.reshape(B, C, 1), D, axis=2)
        x_sel = (lambda x, i, axis: torch.take_along_dim(x, i, dim=axis))(x, idx_e, axis=1)
        g = _silu(x_sel @ w_gate)
        u = x_sel @ w_up
        y = g * u @ w_down
        r_sel = _sigmoid((lambda x, i, axis: torch.take_along_dim(x, i, dim=axis))(r, idx, axis=1))
        y = y * r_sel.reshape(B, C, 1)
        b_off = (torch.arange(B) * S).reshape(B, 1)
        flat_idx = (idx + b_off).reshape(B * C)
        zero = (x * 0.0).reshape(B * S, D)
        upd = _scatter_add(zero, flat_idx, y.reshape(B * C, D), axis=0)
        return x + upd.reshape(B, S, D)
    x = A_u
    mod = (_silu(c) @ w_mod).reshape(c.shape[0], 6, 1, -1)
    sa, ca, ga, sb, cb, gb = (mod[:, 0].clone(), mod[:, 1].clone(), mod[:, 2].clone(), mod[:, 3].clone(), mod[:, 4].clone(), mod[:, 5].clone())
    h = _layernorm(x, axis=-1) * (1 + ca) + sa
    x = x + ga * _A_ref(h, A_log_A_real, A_A_imag, A_C_real, A_C_imag, A_log_dt, A_D_skip)
    h = _layernorm(x, axis=-1) * (1 + cb) + sb
    x = x + gb * _B_ref(h, B_w_r, B_w_gate, B_w_up, B_w_down)
    return x
```

```asm
; @launch grid=(256,1,1) block=(512,1,1) lds=154272
.amdgcn_target "amdgcn-amd-amdhsa--gfx950"
.text
.globl adaLN_cond__ssm_conv_s4d__moe_arch_mod__prompt_kernel
.p2align 8
.type adaLN_cond__ssm_conv_s4d__moe_arch_mod__prompt_kernel,@function
adaLN_cond__ssm_conv_s4d__moe_arch_mod__prompt_kernel:
    s_cmp_ge_u32 s2, 256
    s_cbranch_scc1 L_end
    s_load_dwordx16 s[16:31], s[0:1], 0
    s_load_dwordx16 s[32:47], s[0:1], 64
    s_load_dwordx2 s[48:49], s[0:1], 128
    s_memrealtime s[6:7]
    s_getpc_b64 s[14:15]
    v_and_b32 v1, 63, v0
    v_lshrrev_b32 v2, 6, v0
    s_lshr_b32 s50, s2, 3
    s_and_b32 s51, s2, 7
    v_readfirstlane_b32 s4, v2
    s_lshl_b32 s3, s51, 5
    s_add_u32 s3, s3, s50
    s_lshl_b32 s52, s50, 10
    v_lshl_add_u32 v3, v1, 4, s52
    s_cmp_eq_u32 s4, 6
    s_cselect_b32 s52, s50, 99
    s_cmp_lt_u32 s52, 17
    s_cbranch_scc0 L_nopf
    global_load_dwordx4 v[240:243], v3, s[14:15]
L_nopf:
    s_lshl_b32 s14, s3, 3
    s_add_u32 s14, s14, s4
    s_lshl_b32 s14, s14, 10
    v_lshl_add_u32 v2, v1, 4, s14
    v_mov_b32 v228, 0
    v_mov_b32 v229, 0
    v_mov_b32 v230, 0
    v_mov_b32 v231, 0
    s_lshr_b32 s54, s4, 2
    s_bfe_u32 s55, s4, 0x10001
    s_and_b32 s56, s4, 1
    s_lshl_b32 s14, s3, 1
    s_add_u32 s14, s14, s54
    s_lshl_b32 s14, s14, 7
    s_lshl_b32 s15, s55, 6
    s_add_u32 s14, s14, s15
    v_add_lshl_u32 v12, v1, s14, 1
    s_lshl_b32 s15, s3, 2
    v_mov_b32 v14, 0
    s_cmp_eq_u32 s2, 0
    s_cselect_b32 s53, s4, 1
    s_waitcnt lgkmcnt(0)
    s_mul_i32 s6, s6, 0x9E3779B1
    s_or_b32 s6, s6, 1
    v_mov_b32 v13, s6
    s_cmp_ge_u32 s4, 4
    s_cbranch_scc0 L_noprio
    s_setprio 1
L_noprio:
    s_cmp_eq_u32 s53, 0
    s_cbranch_scc0 L_non0
    global_store_dword v14, v13, s[46:47] sc1
L_non0:
    global_load_dwordx4 v[4:7], v2, s[16:17]
    s_barrier
    global_load_ushort v16, v12, s[18:19]
    global_load_ushort v17, v12, s[20:21]
    global_load_ushort v18, v12, s[22:23]
    global_load_ushort v19, v12, s[24:25]
    s_lshl_b32 s14, s3, 13
    s_add_u32 s14, s14, 2097152
    v_lshl_add_u32 v3, v0, 4, s14
    global_store_dwordx4 v3, v[228:231], s[48:49] sc1
    s_load_dword s12, s[26:27], s15
    s_load_dword s13, s[28:29], s15
    s_mov_b32 s30, s50
    s_mov_b32 s31, s51
    s_cmp_lt_u32 s2, 192
    s_cselect_b32 s92, s2, 999
    s_mul_i32 s14, s31, 11
    s_add_u32 s14, s14, s30
    s_cmp_lt_u32 s30, 11
    s_cselect_b32 s93, s14, 999
    s_lshl_b32 s14, s31, 2
    s_sub_u32 s15, s30, 16
    s_add_u32 s14, s14, s15
    s_cmp_lt_u32 s15, 4
    s_cselect_b32 s94, s14, 999
    v_cmp_gt_u32 vcc, 64, v0
    s_nop 3
    s_and_saveexec_b64 s[52:53], vcc
    v_lshrrev_b32 v2, 5, v0
    v_mul_u32_u24 v2, 4608, v2
    v_and_b32 v3, 31, v0
    v_lshl_add_u32 v2, v3, 4, v2
    v_add_u32 v2, 62016, v2
    ds_write_b128 v2, v[228:231]
    v_and_b32 v2, 1, v0
    v_mul_u32_u24 v2, 1312, v2
    v_add_u32 v2, 81224, v2
    ds_write_b32 v2, v228
    s_mov_b64 exec, s[52:53]
    s_mul_i32 s14, s4, 1088
    s_add_u32 s14, s14, 71232
    v_lshl_add_u32 v232, v1, 4, s14
    v_bfe_u32 v2, v1, 2, 2
    v_mul_u32_u24 v2, 1088, v2
    v_lshrrev_b32 v3, 4, v1
    v_lshlrev_b32 v13, 5, v3
    v_and_b32 v15, 3, v1
    v_lshl_add_u32 v13, v15, 3, v13
    s_lshl_b32 s14, s4, 7
    s_add_u32 s14, s14, 71232
    v_add3_u32 v201, v2, v13, s14
    v_lshrrev_b32 v2, 2, v0
    v_lshlrev_b32 v2, 14, v2
    v_and_b32 v13, 3, v0
    v_lshlrev_b32 v13, 4, v13
    s_lshl_b32 s14, s3, 6
    s_add_u32 s14, s14, 0
    v_add3_u32 v202, v2, v13, s14
    s_mul_i32 s14, s54, 31008
    s_lshl_b32 s15, s55, 8
    s_add_u32 s14, s14, s15
    s_add_u32 s14, s14, 0
    v_lshl_add_u32 v203, v1, 2, s14
    v_mov_b32 v226, 0xfff8fff8
    v_mov_b32 v252, 0
    v_mov_b32 v199, 0
    v_mov_b32 v253, 0
    v_mov_b32 v254, 0
    s_and_b32 s15, s92, 3
    s_lshr_b32 s14, s92, 2
    s_and_b32 s14, s14, 63
    s_min_u32 s14, s14, 47
    s_lshl_b32 s14, s14, 7
    s_mul_i32 s52, s15, 786432
    s_add_u32 s14, s14, s52
    s_mul_i32 s52, s4, 98304
    s_add_u32 s14, s14, s52
    v_lshrrev_b32 v2, 3, v1
    v_and_b32 v3, 7, v1
    v_and_b32 v13, 2, v2
    v_xor_b32 v3, v3, v13
    v_mul_u32_u24 v2, 6144, v2
    v_lshl_add_u32 v233, v3, 4, v2
    v_add_u32 v233, s14, v233
    v_xor_b32 v3, 4, v3
    v_lshl_add_u32 v2, v3, 4, v2
    s_add_u32 s14, s14, 49152
    v_add_u32 v234, s14, v2
    s_lshl_b32 s15, s15, 8
    v_and_b32 v3, 127, v0
    v_lshl_add_u32 v235, v3, 1, s15
    s_lshl_b32 s59, s4, 11
    s_add_u32 s59, s59, 82560
    s_cmp_eq_u32 s4, 7
    s_cbranch_scc0 L_non1
    global_load_dword v15, v14, s[46:47] sc1
    s_waitcnt vmcnt(6)
    s_branch L_xgot
L_non1:
    s_waitcnt vmcnt(5)
L_xgot:
    s_sub_u32 s14, s92, 0
    s_cmp_lt_u32 s14, 64
    s_cbranch_scc0 L_nomodlde
    s_mov_b32 m0, s59
    s_add_u32 s14, s59, 1024
    global_load_lds_dwordx4 v233, s[42:43]
    s_mov_b32 m0, s14
    global_load_ushort v23, v235, s[40:41]
    global_load_lds_dwordx4 v234, s[42:43]
L_nomodlde:
    v_mov_b32 v2, 0x3f803f80
    v_dot2_f32_bf16 v24, v4, v2, 0
    v_dot2_f32_bf16 v25, v4, v4, 0
    v_dot2_f32_bf16 v24, v5, v2, v24
    v_dot2_f32_bf16 v25, v5, v5, v25
    v_dot2_f32_bf16 v24, v6, v2, v24
    v_dot2_f32_bf16 v25, v6, v6, v25
    v_dot2_f32_bf16 v24, v7, v2, v24
    v_dot2_f32_bf16 v25, v7, v7, v25
    s_nop 1
    v_add_f32_dpp v24, v24, v24 row_shr:1 row_mask:0xf bank_mask:0xf bound_ctrl:0
    v_add_f32_dpp v25, v25, v25 row_shr:1 row_mask:0xf bank_mask:0xf bound_ctrl:0
    v_lshlrev_b32 v32, 16, v4
    v_add_f32_dpp v24, v24, v24 row_shr:2 row_mask:0xf bank_mask:0xf bound_ctrl:0
    v_add_f32_dpp v25, v25, v25 row_shr:2 row_mask:0xf bank_mask:0xf bound_ctrl:0
    v_and_b32 v33, 0xffff0000, v4
    v_add_f32_dpp v24, v24, v24 row_shr:4 row_mask:0xf bank_mask:0xf bound_ctrl:0
    v_add_f32_dpp v25, v25, v25 row_shr:4 row_mask:0xf bank_mask:0xf bound_ctrl:0
    v_lshlrev_b32 v34, 16, v5
    v_add_f32_dpp v24, v24, v24 row_shr:8 row_mask:0xf bank_mask:0xf bound_ctrl:0
    v_add_f32_dpp v25, v25, v25 row_shr:8 row_mask:0xf bank_mask:0xf bound_ctrl:0
    v_and_b32 v35, 0xffff0000, v5
    v_add_f32_dpp v24, v24, v24 row_bcast:15 row_mask:0xa bank_mask:0xf
    v_add_f32_dpp v25, v25, v25 row_bcast:15 row_mask:0xa bank_mask:0xf
    v_lshlrev_b32 v36, 16, v6
    v_add_f32_dpp v24, v24, v24 row_bcast:31 row_mask:0xc bank_mask:0xf
    v_add_f32_dpp v25, v25, v25 row_bcast:31 row_mask:0xc bank_mask:0xf
    v_and_b32 v37, 0xffff0000, v6
    v_lshlrev_b32 v38, 16, v7
    v_and_b32 v39, 0xffff0000, v7
    v_readlane_b32 s14, v24, 63
    v_readlane_b32 s15, v25, 63
    v_mov_b32 v27, 0x3b000000
    v_mul_f32 v24, s14, v27
    v_mul_f32 v25, s15, v27
    v_fma_f32 v25, -v24, v24, v25
    v_max_f32 v25, 0, v25
    v_add_f32 v25, 0x3727c5ac, v25
    v_rsq_f32 v25, v25
    s_nop 0
    v_mul_f32 v24, v24, v25
    v_fma_f32 v32, v32, v25, -v24
    v_fma_f32 v33, v33, v25, -v24
    v_fma_f32 v34, v34, v25, -v24
    v_fma_f32 v35, v35, v25, -v24
    v_fma_f32 v36, v36, v25, -v24
    v_fma_f32 v37, v37, v25, -v24
    v_fma_f32 v38, v38, v25, -v24
    v_fma_f32 v39, v39, v25, -v24
    v_cvt_pk_f16_f32 v40, v32, v33
    v_cvt_pk_f16_f32 v41, v34, v35
    v_cvt_pk_f16_f32 v42, v36, v37
    v_cvt_pk_f16_f32 v43, v38, v39
    v_add_u32 v40, 0x00040004, v40
    v_add_u32 v41, 0x00040004, v41
    v_add_u32 v42, 0x00040004, v42
    v_add_u32 v43, 0x00040004, v43
    ds_write_b128 v232, v[40:43]
    s_cmp_ge_u32 s4, 3
    s_cselect_b32 s14, 1, 0
    s_mul_i32 s15, s14, 3
    s_sub_u32 s57, s4, s15
    s_mul_i32 s53, s14, 31008
    v_and_b32 v2, 15, v1
    v_lshrrev_b32 v3, 4, v1
    v_mul_u32_u24 v13, 544, v2
    v_lshl_add_u32 v13, v3, 4, v13
    s_mul_i32 s58, s57, 8704
    s_add_u32 s58, s58, s53
    v_add_u32 v204, s58, v13
    s_add_u32 s53, s53, 22304
    v_add_u32 v205, s53, v13
    s_mul_i32 s14, s14, 1312
    s_add_u32 s14, s14, 79936
    v_cmp_le_u32 vcc, 2, v3
    s_cmp_eq_u32 s57, 1
    s_cbranch_scc1 L_kt1
    s_cmp_eq_u32 s57, 2
    s_cbranch_scc1 L_kt2
    v_lshrrev_b32 v24, 1, v3
    v_lshlrev_b32 v24, 7, v24
    v_and_b32 v25, 1, v3
    v_lshl_add_u32 v24, v25, 2, v24
    v_lshl_add_u32 v24, v2, 3, v24
    v_lshl_add_u32 v206, v24, 1, s14
    v_add_u32 v207, 2, v206
    v_add_u32 v208, 4, v206
    v_add_u32 v209, 6, v206
    s_branch L_kt3
L_kt1:
    v_lshlrev_b32 v25, 6, v3
    v_lshl_add_u32 v26, v2, 2, v25
    v_lshl_add_u32 v27, v2, 1, v25
    v_cndmask_b32 v26, v26, v27, vcc
    v_add_u32 v26, 256, v26
    v_lshl_add_u32 v206, v26, 1, s14
    v_add_u32 v207, 2, v206
    v_mov_b32 v24, 4
    v_mov_b32 v25, 64
    v_cndmask_b32 v24, v24, v25, vcc
    v_add_u32 v208, v24, v206
    v_add_u32 v209, 2, v208
    s_branch L_kt3
L_kt2:
    v_lshl_add_u32 v24, v3, 6, v2
    v_add_u32 v24, 512, v24
    v_lshl_add_u32 v206, v24, 1, s14
    v_add_u32 v207, 32, v206
    v_add_u32 v208, 64, v206
    v_add_u32 v209, 96, v206
    s_add_u32 s15, s14, 1300
    v_mov_b32 v25, s15
    v_cndmask_b32 v206, v206, v25, vcc
    v_cndmask_b32 v207, v207, v25, vcc
    v_cndmask_b32 v208, v208, v25, vcc
    v_cndmask_b32 v209, v209, v25, vcc
    s_add_u32 s15, s14, 1280
    v_mov_b32 v25, s15
    v_cmp_eq_u32 vcc, 32, v1
    s_nop 1
    v_cndmask_b32 v206, v206, v25, vcc
L_kt3:
    s_lshl_b32 s14, s3, 4
    s_add_u32 s14, s14, 7340032
    v_and_b32 v2, 3, v1
    v_mul_u32_u24 v2, 24576, v2
    v_bfe_u32 v3, v1, 2, 1
    v_lshl_add_u32 v2, v3, 12, v2
    v_add_u32 v255, s14, v2
    s_lshr_b32 s14, s3, 1
    s_lshl_b32 s14, s14, 14
    s_and_b32 s15, s3, 1
    s_lshl_b32 s15, s15, 5
    s_add_u32 s14, s14, s15
    s_add_u32 s14, s14, 0
    v_lshrrev_b32 v3, 1, v0
    v_lshlrev_b32 v13, 6, v3
    v_and_b32 v14, 1, v0
    v_lshl_add_u32 v13, v14, 4, v13
    v_add_u32 v222, s14, v13
    v_mov_b32 v14, 0
    s_cmp_ge_u32 s92, 64
    s_cbranch_scc1 L_nw0
    s_waitcnt vmcnt(3)
    s_branch L_nw1
L_nw0:
    s_waitcnt vmcnt(0)
L_nw1:
    s_cmp_eq_u32 s4, 7
    s_cbranch_scc0 L_non2
    v_readfirstlane_b32 s15, v15
    s_mov_b32 s14, 0
    s_nop 2
    s_cmp_lg_u32 s15, 0
    s_cbranch_scc0 L_npoll
L_ngot:
    v_mov_b32 v2, 142976
    v_mov_b32 v3, s15
    ds_write_b32 v2, v3
L_non2:
    s_waitcnt lgkmcnt(0)
    s_barrier
    v_mov_b32 v2, 142976
    ds_read_b32 v3, v2
    ds_read_b64_tr_b16 v[40:41], v201
    ds_read_b64_tr_b16 v[42:43], v201 offset:4352
    s_waitcnt lgkmcnt(2)
    v_readfirstlane_b32 s5, v3
    s_nop 3
    s_and_b32 s8, s5, 0x00070007
    s_lshr_b32 s9, s5, 3
    s_and_b32 s9, s9, 0x00070007
    s_lshr_b32 s10, s5, 6
    s_and_b32 s10, s10, 0x00070007
    s_lshr_b32 s11, s5, 9
    s_and_b32 s11, s11, 0x00070007
    s_waitcnt lgkmcnt(0)
    v_and_or_b32 v40, v40, v226, s8
    v_and_or_b32 v41, v41, v226, s9
    v_and_or_b32 v42, v42, v226, s10
    v_and_or_b32 v43, v43, v226, s11
    global_store_dwordx4 v202, v[40:43], s[48:49] sc1
    s_sub_u32 s14, s92, 64
    s_cmp_lt_u32 s14, 128
    s_cbranch_scc0 L_nomodldl
    s_mov_b32 m0, s59
    s_add_u32 s14, s59, 1024
    global_load_lds_dwordx4 v233, s[42:43]
    s_mov_b32 m0, s14
    global_load_ushort v23, v235, s[40:41]
    global_load_lds_dwordx4 v234, s[42:43]
L_nomodldl:
    s_cmp_lt_u32 s92, 64
    s_cbranch_scc0 L_noearly
    s_cmp_ge_u32 s4, 6
    s_cbranch_scc0 L_noma
    s_sub_u32 s14, s4, 6
    v_lshrrev_b32 v3, 4, v1
    v_bfe_u32 v2, v1, 2, 2
    v_lshl_add_u32 v13, v3, 3, v2
    v_lshlrev_b32 v13, 7, v13
    v_and_b32 v14, 1, v1
    v_lshl_add_u32 v13, v14, 3, v13
    v_and_b32 v2, 2, v2
    v_and_b32 v14, 1, v3
    v_lshl_add_u32 v2, v14, 2, v2
    v_bfe_u32 v14, v1, 1, 1
    s_lshl_b32 s15, s14, 2
    v_add_u32 v14, s15, v14
    v_xor_b32 v24, v14, v2
    v_lshl_add_u32 v24, v24, 4, v13
    v_add_u32 v196, 82560, v24
    v_add_u32 v14, 2, v14
    v_xor_b32 v25, v14, v2
    v_lshl_add_u32 v25, v25, 4, v13
    v_add_u32 v197, 82560, v25
    v_lshlrev_b32 v14, 4, v3
    v_add_u32 v198, 143040, v14
    s_sub_u32 s14, s4, 6
    s_and_b32 s15, s92, 3
    s_mul_i32 s15, s15, 24576
    s_lshr_b32 s52, s92, 2
    s_lshl_b32 s52, s52, 9
    s_add_u32 s15, s15, s52
    s_lshl_b32 s14, s14, 8
    s_add_u32 s15, s15, s14
    s_add_u32 s15, s15, 7340032
    v_lshl_add_u32 v199, v1, 4, s15
L_noma:
    s_sub_u32 s14, s92, 0
    s_cmp_lt_u32 s14, 64
    s_cbranch_scc0 L_noscx
    s_waitcnt vmcnt(1)
    v_lshlrev_b32 v23, 16, v23
    v_mul_f32 v2, 0xbfb8aa3b, v23
    v_exp_f32 v2, v2
    v_and_b32 v3, 127, v0
    v_lshlrev_b32 v3, 1, v3
    v_add_f32 v2, 1.0, v2
    v_rcp_f32 v2, v2
    v_add_u32 v3, 143040, v3
    v_mul_f32 v2, v2, v23
    v_cvt_pk_bf16_f32 v2, v2, v2
    ds_write_b16 v3, v2
L_noscx:
    s_waitcnt lgkmcnt(0)
    s_barrier
    s_cmp_ge_u32 s4, 6
    s_cbranch_scc0 L_noearly
    s_sub_u32 s14, s92, 0
    s_cmp_lt_u32 s14, 64
    s_cbranch_scc0 L_noearly
    ds_read_b128 v[64:67], v198 offset:0
    ds_read_b64_tr_b16 v[32:33], v196 offset:0
    ds_read_b64_tr_b16 v[34:35], v196 offset:512
    ds_read_b64_tr_b16 v[36:37], v197 offset:0
    ds_read_b64_tr_b16 v[38:39], v197 offset:512
    ds_read_b128 v[68:71], v198 offset:64
    ds_read_b64_tr_b16 v[40:41], v196 offset:4096
    ds_read_b64_tr_b16 v[42:43], v196 offset:4608
    ds_read_b64_tr_b16 v[44:45], v197 offset:4096
    ds_read_b64_tr_b16 v[46:47], v197 offset:4608
    ds_read_b128 v[72:75], v198 offset:128
    ds_read_b64_tr_b16 v[48:49], v196 offset:8192
    ds_read_b64_tr_b16 v[50:51], v196 offset:8704
    ds_read_b64_tr_b16 v[52:53], v197 offset:8192
    ds_read_b64_tr_b16 v[54:55], v197 offset:8704
    ds_read_b128 v[76:79], v198 offset:192
    ds_read_b64_tr_b16 v[56:57], v196 offset:12288
    ds_read_b64_tr_b16 v[58:59], v196 offset:12800
    ds_read_b64_tr_b16 v[60:61], v197 offset:12288
    ds_read_b64_tr_b16 v[62:63], v197 offset:12800
    v_lshlrev_b32 v3, 3, v1
    v_add_u32 v13, 4, v3
    s_waitcnt lgkmcnt(14)
    v_mfma_f32_16x16x32_bf16 v[80:83], v[64:67], v[32:35], 0
    v_mfma_f32_16x16x32_bf16 v[84:87], v[64:67], v[36:39], 0
    s_waitcnt lgkmcnt(10)
    v_mfma_f32_16x16x32_bf16 v[80:83], v[68:71], v[40:43], v[80:83]
    v_mfma_f32_16x16x32_bf16 v[84:87], v[68:71], v[44:47], v[84:87]
    s_waitcnt lgkmcnt(5)
    v_mfma_f32_16x16x32_bf16 v[80:83], v[72:75], v[48:51], v[80:83]
    v_mfma_f32_16x16x32_bf16 v[84:87], v[72:75], v[52:55], v[84:87]
    s_waitcnt lgkmcnt(0)
    v_mfma_f32_16x16x32_bf16 v[80:83], v[76:79], v[56:59], v[80:83]
    v_mfma_f32_16x16x32_bf16 v[84:87], v[76:79], v[60:63], v[84:87]
    s_nop 7
    v_permlane16_swap_b32 v80, v84
    s_nop 1
    ds_bpermute_b32 v32, v3, v80
    ds_bpermute_b32 v33, v13, v80
    v_mov_b32 v34, s5
    v_mov_b32 v35, s5
    s_mov_b64 s[52:53], exec
    s_mov_b64 exec, 0xffff
    s_waitcnt lgkmcnt(0)
    global_store_dwordx4 v199, v[32:35], s[48:49] sc1
    s_mov_b64 exec, s[52:53]
L_noearly:
    s_cmp_ge_u32 s92, 192
    s_cbranch_scc1 L_kw2
    s_waitcnt vmcnt(4) lgkmcnt(0)
    s_branch L_kw5
L_kw2:
    s_waitcnt vmcnt(1) lgkmcnt(0)
L_kw5:
    s_lshl_b32 s14, s54, 4
    s_lshr_b32 s14, s12, s14
    s_lshl_b32 s14, s14, 16
    v_mov_b32 v2, 0x3fb8aa3b
    v_mul_f32 v24, s14, v2
    v_lshlrev_b32 v16, 16, v16
    v_exp_f32 v24, v24
    v_mul_f32 v16, v16, v2
    v_lshlrev_b32 v17, 16, v17
    v_exp_f32 v16, v16
    v_lshlrev_b32 v18, 16, v18
    v_cvt_pk_bf16_f32 v24, v24, v24
    v_lshlrev_b32 v19, 16, v19
    v_cvt_pk_bf16_f32 v16, v16, v16
    v_and_b32 v24, 0xffff0000, v24
    v_and_b32 v16, 0xffff0000, v16
    v_mul_f32 v17, v17, v24
    v_mul_f32 v16, v16, v24
    v_mul_f32 v17, 0x3e22f983, v17
    v_mul_f32 v16, 0xbfb8aa3b, v16
    v_add_f32 v24, v24, v24
    v_mul_f32 v26, v18, v24
    v_mul_f32 v27, v19, v24
    s_cmp_eq_u32 s56, 0
    s_cselect_b32 s14, 0x3f800000, 0x40000000
    s_cselect_b32 s15, 0x41000000, 0x40800000
    v_mul_f32 v40, s14, v16
    v_mul_f32 v42, s15, v16
    v_mul_f32 v44, 0x43000000, v16
    v_mul_f32 v41, s14, v17
    v_mul_f32 v43, s15, v17
    v_mul_f32 v45, 0x43000000, v17
    v_exp_f32 v40, v40
    v_exp_f32 v42, v42
    v_exp_f32 v44, v44
    v_fract_f32 v41, v41
    v_fract_f32 v43, v43
    v_fract_f32 v45, v45
    v_cos_f32 v32, v41
    v_cos_f32 v34, v43
    v_cos_f32 v36, v45
    v_sin_f32 v33, v41
    v_sin_f32 v35, v43
    v_sin_f32 v37, v45
    v_mul_f32 v32, v32, v40
    v_mul_f32 v34, v34, v42
    v_mul_f32 v36, v36, v44
    v_mul_f32 v33, v33, v40
    v_mul_f32 v35, v35, v42
    v_mul_f32 v37, v37, v44
    s_cmp_eq_u32 s56, 0
    s_cbranch_scc0 L_kg1
    v_cvt_pk_bf16_f32 v30, v26, -v27
    ds_write_b32 v203, v30 offset:22304
    v_pk_mul_f32 v[62:63], v[34:35], v[34:35] op_sel:[0,0] op_sel_hi:[1,0]
    v_pk_fma_f32 v[62:63], v[34:35], v[34:35], v[62:63] op_sel:[1,1,0] op_sel_hi:[0,1,1] neg_lo:[1,0,0]
    v_mov_b32 v28, 0x00003f80
    v_pk_mul_f32 v[66:67], v[26:27], v[62:63] op_sel:[0,0] op_sel_hi:[1,0]
    v_pk_mul_f32 v[68:69], v[26:27], v[34:35] op_sel:[0,0] op_sel_hi:[1,0]
    ds_write_b32 v203, v28 offset:0
    v_pk_fma_f32 v[66:67], v[26:27], v[62:63], v[66:67] op_sel:[1,1,0] op_sel_hi:[0,1,1] neg_lo:[1,0,0]
    v_pk_fma_f32 v[68:69], v[26:27], v[34:35], v[68:69] op_sel:[1,1,0] op_sel_hi:[0,1,1] neg_lo:[1,0,0]
    v_cvt_pk_bf16_f32 v28, v32, v33
    v_cvt_pk_bf16_f32 v31, v66, -v67
    v_cvt_pk_bf16_f32 v44, v68, -v69
    ds_write_b32 v203, v28 offset:544
    ds_write_b32 v203, v31 offset:23392
    ds_write_b32 v203, v44 offset:22848
    v_cvt_pk_bf16_f32 v29, v36, v37
    v_pk_mul_f32 v[64:65], v[66:67], v[62:63] op_sel:[0,0] op_sel_hi:[1,0]
    v_pk_mul_f32 v[72:73], v[68:69], v[62:63] op_sel:[0,0] op_sel_hi:[1,0]
    ds_write_b32 v203, v29 offset:4352
    v_pk_fma_f32 v[64:65], v[66:67], v[62:63], v[64:65] op_sel:[1,1,0] op_sel_hi:[0,1,1] neg_lo:[1,0,0]
    v_pk_fma_f32 v[72:73], v[68:69], v[62:63], v[72:73] op_sel:[1,1,0] op_sel_hi:[0,1,1] neg_lo:[1,0,0]
    v_pk_mul_f32 v[46:47], v[32:33], v[32:33] op_sel:[0,0] op_sel_hi:[1,0]
    v_cvt_pk_bf16_f32 v30, v64, -v65
    v_cvt_pk_bf16_f32 v45, v72, -v73
    v_pk_fma_f32 v[46:47], v[32:33], v[32:33], v[46:47] op_sel:[1,1,0] op_sel_hi:[0,1,1] neg_lo:[1,0,0]
    ds_write_b32 v203, v30 offset:24480
    ds_write_b32 v203, v45 offset:23936
    v_cvt_pk_bf16_f32 v28, v46, v47
    v_pk_mul_f32 v[66:67], v[64:65], v[62:63] op_sel:[0,0] op_sel_hi:[1,0]
    v_pk_mul_f32 v[70:71], v[72:73], v[62:63] op_sel:[0,0] op_sel_hi:[1,0]
    ds_write_b32 v203, v28 offset:1088
    v_pk_fma_f32 v[66:67], v[64:65], v[62:63], v[66:67] op_sel:[1,1,0] op_sel_hi:[0,1,1] neg_lo:[1,0,0]
    v_pk_fma_f32 v[70:71], v[72:73], v[62:63], v[70:71] op_sel:[1,1,0] op_sel_hi:[0,1,1] neg_lo:[1,0,0]
    v_pk_mul_f32 v[48:49], v[46:47], v[32:33] op_sel:[0,0] op_sel_hi:[1,0]
    v_cvt_pk_bf16_f32 v31, v66, -v67
    v_cvt_pk_bf16_f32 v44, v70, -v71
    v_pk_fma_f32 v[48:49], v[46:47], v[32:33], v[48:49] op_sel:[1,1,0] op_sel_hi:[0,1,1] neg_lo:[1,0,0]
    ds_write_b32 v203, v31 offset:25568
    ds_write_b32 v203, v44 offset:25024
    v_cvt_pk_bf16_f32 v29, v48, v49
    v_pk_mul_f32 v[64:65], v[66:67], v[62:63] op_sel:[0,0] op_sel_hi:[1,0]
    v_pk_mul_f32 v[72:73], v[70:71], v[62:63] op_sel:[0,0] op_sel_hi:[1,0]
    ds_write_b32 v203, v29 offset:1632
    v_pk_fma_f32 v[64:65], v[66:67], v[62:63], v[64:65] op_sel:[1,1,0] op_sel_hi:[0,1,1] neg_lo:[1,0,0]
    v_pk_fma_f32 v[72:73], v[70:71], v[62:63], v[72:73] op_sel:[1,1,0] op_sel_hi:[0,1,1] neg_lo:[1,0,0]
    v_pk_mul_f32 v[50:51], v[48:49], v[32:33] op_sel:[0,0] op_sel_hi:[1,0]
    v_cvt_pk_bf16_f32 v30, v64, -v65
    v_cvt_pk_bf16_f32 v45, v72, -v73
    v_pk_fma_f32 v[50:51], v[48:49], v[32:33], v[50:51] op_sel:[1,1,0] op_sel_hi:[0,1,1] neg_lo:[1,0,0]
    ds_write_b32 v203, v30 offset:26656
    ds_write_b32 v203, v45 offset:26112
    v_cvt_pk_bf16_f32 v28, v50, v51
    v_pk_mul_f32 v[66:67], v[64:65], v[62:63] op_sel:[0,0] op_sel_hi:[1,0]
    v_pk_mul_f32 v[70:71], v[72:73], v[62:63] op_sel:[0,0] op_sel_hi:[1,0]
    ds_write_b32 v203, v28 offset:2176
    v_pk_fma_f32 v[66:67], v[64:65], v[62:63], v[66:67] op_sel:[1,1,0] op_sel_hi:[0,1,1] neg_lo:[1,0,0]
    v_pk_fma_f32 v[70:71], v[72:73], v[62:63], v[70:71] op_sel:[1,1,0] op_sel_hi:[0,1,1] neg_lo:[1,0,0]
    v_pk_mul_f32 v[52:53], v[50:51], v[32:33] op_sel:[0,0] op_sel_hi:[1,0]
    v_cvt_pk_bf16_f32 v31, v66, -v67
    v_cvt_pk_bf16_f32 v44, v70, -v71
    v_pk_fma_f32 v[52:53], v[50:51], v[32:33], v[52:53] op_sel:[1,1,0] op_sel_hi:[0,1,1] neg_lo:[1,0,0]
    ds_write_b32 v203, v31 offset:27744
    ds_write_b32 v203, v44 offset:27200
    v_cvt_pk_bf16_f32 v29, v52, v53
    v_pk_mul_f32 v[64:65], v[66:67], v[62:63] op_sel:[0,0] op_sel_hi:[1,0]
    v_pk_mul_f32 v[72:73], v[70:71], v[62:63] op_sel:[0,0] op_sel_hi:[1,0]
    ds_write_b32 v203, v29 offset:2720
    v_pk_fma_f32 v[64:65], v[66:67], v[62:63], v[64:65] op_sel:[1,1,0] op_sel_hi:[0,1,1] neg_lo:[1,0,0]
    v_pk_fma_f32 v[72:73], v[70:71], v[62:63], v[72:73] op_sel:[1,1,0] op_sel_hi:[0,1,1] neg_lo:[1,0,0]
    v_pk_mul_f32 v[54:55], v[52:53], v[32:33] op_sel:[0,0] op_sel_hi:[1,0]
    v_cvt_pk_bf16_f32 v30, v64, -v65
    v_cvt_pk_bf16_f32 v45, v72, -v73
    v_pk_fma_f32 v[54:55], v[52:53], v[32:33], v[54:55] op_sel:[1,1,0] op_sel_hi:[0,1,1] neg_lo:[1,0,0]
    ds_write_b32 v203, v30 offset:28832
    ds_write_b32 v203, v45 offset:28288
    v_cvt_pk_bf16_f32 v28, v54, v55
    v_pk_mul_f32 v[66:67], v[64:65], v[62:63] op_sel:[0,0] op_sel_hi:[1,0]
    v_pk_mul_f32 v[70:71], v[72:73], v[62:63] op_sel:[0,0] op_sel_hi:[1,0]
    ds_write_b32 v203, v28 offset:3264
    v_pk_fma_f32 v[66:67], v[64:65], v[62:63], v[66:67] op_sel:[1,1,0] op_sel_hi:[0,1,1] neg_lo:[1,0,0]
    v_pk_fma_f32 v[70:71], v[72:73], v[62:63], v[70:71] op_sel:[1,1,0] op_sel_hi:[0,1,1] neg_lo:[1,0,0]
    v_pk_mul_f32 v[56:57], v[54:55], v[32:33] op_sel:[0,0] op_sel_hi:[1,0]
    v_cvt_pk_bf16_f32 v31, v66, -v67
    v_cvt_pk_bf16_f32 v44, v70, -v71
    v_pk_fma_f32 v[56:57], v[54:55], v[32:33], v[56:57] op_sel:[1,1,0] op_sel_hi:[0,1,1] neg_lo:[1,0,0]
    ds_write_b32 v203, v31 offset:29920
    ds_write_b32 v203, v44 offset:29376
    v_cvt_pk_bf16_f32 v29, v56, v57
    v_pk_mul_f32 v[72:73], v[70:71], v[62:63] op_sel:[0,0] op_sel_hi:[1,0]
    ds_write_b32 v203, v29 offset:3808
    v_pk_fma_f32 v[72:73], v[70:71], v[62:63], v[72:73] op_sel:[1,1,0] op_sel_hi:[0,1,1] neg_lo:[1,0,0]
    v_pk_mul_f32 v[60:61], v[36:37], v[32:33] op_sel:[0,0] op_sel_hi:[1,0]
    v_cvt_pk_bf16_f32 v45, v72, -v73
    v_pk_fma_f32 v[60:61], v[36:37], v[32:33], v[60:61] op_sel:[1,1,0] op_sel_hi:[0,1,1] neg_lo:[1,0,0]
    ds_write_b32 v203, v45 offset:30464
    v_cvt_pk_bf16_f32 v28, v60, v61
    ds_write_b32 v203, v28 offset:4896
    v_pk_mul_f32 v[58:59], v[36:37], v[46:47] op_sel:[0,0] op_sel_hi:[1,0]
    v_pk_fma_f32 v[58:59], v[36:37], v[46:47], v[58:59] op_sel:[1,1,0] op_sel_hi:[0,1,1] neg_lo:[1,0,0]
    v_cvt_pk_bf16_f32 v29, v58, v59
    ds_write_b32 v203, v29 offset:5440
    v_pk_mul_f32 v[60:61], v[36:37], v[48:49] op_sel:[0,0] op_sel_hi:[1,0]
    v_pk_fma_f32 v[60:61], v[36:37], v[48:49], v[60:61] op_sel:[1,1,0] op_sel_hi:[0,1,1] neg_lo:[1,0,0]
    v_cvt_pk_bf16_f32 v28, v60, v61
    ds_write_b32 v203, v28 offset:5984
    v_pk_mul_f32 v[58:59], v[36:37], v[50:51] op_sel:[0,0] op_sel_hi:[1,0]
    v_pk_fma_f32 v[58:59], v[36:37], v[50:51], v[58:59] op_sel:[1,1,0] op_sel_hi:[0,1,1] neg_lo:[1,0,0]
    v_cvt_pk_bf16_f32 v29, v58, v59
    ds_write_b32 v203, v29 offset:6528
    v_pk_mul_f32 v[60:61], v[36:37], v[52:53] op_sel:[0,0] op_sel_hi:[1,0]
    v_pk_fma_f32 v[60:61], v[36:37], v[52:53], v[60:61] op_sel:[1,1,0] op_sel_hi:[0,1,1] neg_lo:[1,0,0]
    v_cvt_pk_bf16_f32 v28, v60, v61
    ds_write_b32 v203, v28 offset:7072
    v_pk_mul_f32 v[58:59], v[36:37], v[54:55] op_sel:[0,0] op_sel_hi:[1,0]
    v_pk_fma_f32 v[58:59], v[36:37], v[54:55], v[58:59] op_sel:[1,1,0] op_sel_hi:[0,1,1] neg_lo:[1,0,0]
    v_cvt_pk_bf16_f32 v29, v58, v59
    ds_write_b32 v203, v29 offset:7616
    v_pk_mul_f32 v[60:61], v[36:37], v[56:57] op_sel:[0,0] op_sel_hi:[1,0]
    v_pk_fma_f32 v[60:61], v[36:37], v[56:57], v[60:61] op_sel:[1,1,0] op_sel_hi:[0,1,1] neg_lo:[1,0,0]
    v_cvt_pk_bf16_f32 v28, v60, v61
    ds_write_b32 v203, v28 offset:8160
    s_branch L_kg2
L_kg1:
    v_pk_mul_f32 v[46:47], v[34:35], v[32:33] op_sel:[0,0] op_sel_hi:[1,0]
    v_pk_mul_f32 v[48:49], v[36:37], v[36:37] op_sel:[0,0] op_sel_hi:[1,0]
    v_pk_fma_f32 v[46:47], v[34:35], v[32:33], v[46:47] op_sel:[1,1,0] op_sel_hi:[0,1,1] neg_lo:[1,0,0]
    v_pk_fma_f32 v[48:49], v[36:37], v[36:37], v[48:49] op_sel:[1,1,0] op_sel_hi:[0,1,1] neg_lo:[1,0,0]
    v_pk_mul_f32 v[50:51], v[48:49], v[36:37] op_sel:[0,0] op_sel_hi:[1,0]
    v_pk_mul_f32 v[52:53], v[48:49], v[48:49] op_sel:[0,0] op_sel_hi:[1,0]
    v_pk_fma_f32 v[50:51], v[48:49], v[36:37], v[50:51] op_sel:[1,1,0] op_sel_hi:[0,1,1] neg_lo:[1,0,0]
    v_pk_fma_f32 v[52:53], v[48:49], v[48:49], v[52:53] op_sel:[1,1,0] op_sel_hi:[0,1,1] neg_lo:[1,0,0]
    v_pk_mul_f32 v[54:55], v[52:53], v[52:53] op_sel:[0,0] op_sel_hi:[1,0]
    v_pk_fma_f32 v[54:55], v[52:53], v[52:53], v[54:55] op_sel:[1,1,0] op_sel_hi:[0,1,1] neg_lo:[1,0,0]
    v_cvt_pk_bf16_f32 v28, v48, v49
    v_cvt_pk_bf16_f32 v30, v52, v53
    v_cvt_pk_bf16_f32 v44, v54, v55
    ds_write_b32 v203, v28 offset:8704
    ds_write_b32 v203, v30 offset:13056
    ds_write_b32 v203, v44 offset:17408
    v_cvt_pk_bf16_f32 v29, v50, v51
    v_pk_mul_f32 v[60:61], v[52:53], v[34:35] op_sel:[0,0] op_sel_hi:[1,0]
    v_pk_mul_f32 v[66:67], v[54:55], v[54:55] op_sel:[0,0] op_sel_hi:[1,0]
    ds_write_b32 v203, v29 offset:10880
    v_pk_fma_f32 v[60:61], v[52:53], v[34:35], v[60:61] op_sel:[1,1,0] op_sel_hi:[0,1,1] neg_lo:[1,0,0]
    v_pk_fma_f32 v[66:67], v[54:55], v[54:55], v[66:67] op_sel:[1,1,0] op_sel_hi:[0,1,1] neg_lo:[1,0,0]
    v_pk_mul_f32 v[58:59], v[48:49], v[32:33] op_sel:[0,0] op_sel_hi:[1,0]
    v_cvt_pk_bf16_f32 v31, v60, v61
    v_cvt_pk_bf16_f32 v45, v66, v67
    v_pk_fma_f32 v[58:59], v[48:49], v[32:33], v[58:59] op_sel:[1,1,0] op_sel_hi:[0,1,1] neg_lo:[1,0,0]
    ds_write_b32 v203, v31 offset:13600
    ds_write_b32 v203, v45 offset:21760
    v_cvt_pk_bf16_f32 v28, v58, v59
    v_pk_mul_f32 v[62:63], v[52:53], v[36:37] op_sel:[0,0] op_sel_hi:[1,0]
    v_pk_mul_f32 v[70:71], v[54:55], v[36:37] op_sel:[0,0] op_sel_hi:[1,0]
    ds_write_b32 v203, v28 offset:9248
    v_pk_fma_f32 v[62:63], v[52:53], v[36:37], v[62:63] op_sel:[1,1,0] op_sel_hi:[0,1,1] neg_lo:[1,0,0]
    v_pk_fma_f32 v[70:71], v[54:55], v[36:37], v[70:71] op_sel:[1,1,0] op_sel_hi:[0,1,1] neg_lo:[1,0,0]
    v_pk_mul_f32 v[56:57], v[48:49], v[34:35] op_sel:[0,0] op_sel_hi:[1,0]
    v_cvt_pk_bf16_f32 v30, v62, v63
    v_cvt_pk_bf16_f32 v44, v70, v71
    v_pk_fma_f32 v[56:57], v[48:49], v[34:35], v[56:57] op_sel:[1,1,0] op_sel_hi:[0,1,1] neg_lo:[1,0,0]
    ds_write_b32 v203, v30 offset:14144
    ds_write_b32 v203, v44 offset:17952
    v_cvt_pk_bf16_f32 v29, v56, v57
    v_pk_mul_f32 v[60:61], v[62:63], v[34:35] op_sel:[0,0] op_sel_hi:[1,0]
    v_pk_mul_f32 v[68:69], v[70:71], v[36:37] op_sel:[0,0] op_sel_hi:[1,0]
    ds_write_b32 v203, v29 offset:9792
    v_pk_fma_f32 v[60:61], v[62:63], v[34:35], v[60:61] op_sel:[1,1,0] op_sel_hi:[0,1,1] neg_lo:[1,0,0]
    v_pk_fma_f32 v[68:69], v[70:71], v[36:37], v[68:69] op_sel:[1,1,0] op_sel_hi:[0,1,1] neg_lo:[1,0,0]
    v_pk_mul_f32 v[58:59], v[48:49], v[46:47] op_sel:[0,0] op_sel_hi:[1,0]
    v_cvt_pk_bf16_f32 v31, v60, v61
    v_cvt_pk_bf16_f32 v45, v68, v69
    v_pk_fma_f32 v[58:59], v[48:49], v[46:47], v[58:59] op_sel:[1,1,0] op_sel_hi:[0,1,1] neg_lo:[1,0,0]
    ds_write_b32 v203, v31 offset:14688
    ds_write_b32 v203, v45 offset:18496
    v_cvt_pk_bf16_f32 v28, v58, v59
    v_pk_mul_f32 v[64:65], v[62:63], v[36:37] op_sel:[0,0] op_sel_hi:[1,0]
    v_pk_mul_f32 v[70:71], v[68:69], v[36:37] op_sel:[0,0] op_sel_hi:[1,0]
    ds_write_b32 v203, v28 offset:10336
    v_pk_fma_f32 v[64:65], v[62:63], v[36:37], v[64:65] op_sel:[1,1,0] op_sel_hi:[0,1,1] neg_lo:[1,0,0]
    v_pk_fma_f32 v[70:71], v[68:69], v[36:37], v[70:71] op_sel:[1,1,0] op_sel_hi:[0,1,1] neg_lo:[1,0,0]
    v_pk_mul_f32 v[58:59], v[50:51], v[32:33] op_sel:[0,0] op_sel_hi:[1,0]
    v_cvt_pk_bf16_f32 v30, v64, v65
    v_cvt_pk_bf16_f32 v44, v70, v71
    v_pk_fma_f32 v[58:59], v[50:51], v[32:33], v[58:59] op_sel:[1,1,0] op_sel_hi:[0,1,1] neg_lo:[1,0,0]
    ds_write_b32 v203, v30 offset:15232
    ds_write_b32 v203, v44 offset:19040
    v_cvt_pk_bf16_f32 v29, v58, v59
    v_pk_mul_f32 v[60:61], v[64:65], v[34:35] op_sel:[0,0] op_sel_hi:[1,0]
    v_pk_mul_f32 v[68:69], v[70:71], v[36:37] op_sel:[0,0] op_sel_hi:[1,0]
    ds_write_b32 v203, v29 offset:11424
    v_pk_fma_f32 v[60:61], v[64:65], v[34:35], v[60:61] op_sel:[1,1,0] op_sel_hi:[0,1,1] neg_lo:[1,0,0]
    v_pk_fma_f32 v[68:69], v[70:71], v[36:37], v[68:69] op_sel:[1,1,0] op_sel_hi:[0,1,1] neg_lo:[1,0,0]
    v_pk_mul_f32 v[56:57], v[50:51], v[34:35] op_sel:[0,0] op_sel_hi:[1,0]
    v_cvt_pk_bf16_f32 v31, v60, v61
    v_cvt_pk_bf16_f32 v45, v68, v69
    v_pk_fma_f32 v[56:57], v[50:51], v[34:35], v[56:57] op_sel:[1,1,0] op_sel_hi:[0,1,1] neg_lo:[1,0,0]
    ds_write_b32 v203, v31 offset:15776
    ds_write_b32 v203, v45 offset:19584
    v_cvt_pk_bf16_f32 v28, v56, v57
    v_pk_mul_f32 v[62:63], v[64:65], v[36:37] op_sel:[0,0] op_sel_hi:[1,0]
    v_pk_mul_f32 v[70:71], v[68:69], v[36:37] op_sel:[0,0] op_sel_hi:[1,0]
    ds_write_b32 v203, v28 offset:11968
    v_pk_fma_f32 v[62:63], v[64:65], v[36:37], v[62:63] op_sel:[1,1,0] op_sel_hi:[0,1,1] neg_lo:[1,0,0]
    v_pk_fma_f32 v[70:71], v[68:69], v[36:37], v[70:71] op_sel:[1,1,0] op_sel_hi:[0,1,1] neg_lo:[1,0,0]
    v_pk_mul_f32 v[58:59], v[50:51], v[46:47] op_sel:[0,0] op_sel_hi:[1,0]
    v_cvt_pk_bf16_f32 v30, v62, v63
    v_cvt_pk_bf16_f32 v44, v70, v71
    v_pk_fma_f32 v[58:59], v[50:51], v[46:47], v[58:59] op_sel:[1,1,0] op_sel_hi:[0,1,1] neg_lo:[1,0,0]
    ds_write_b32 v203, v30 offset:16320
    ds_write_b32 v203, v44 offset:20128
    v_cvt_pk_bf16_f32 v29, v58, v59
    v_pk_mul_f32 v[60:61], v[62:63], v[34:35] op_sel:[0,0] op_sel_hi:[1,0]
    v_pk_mul_f32 v[68:69], v[70:71], v[36:37] op_sel:[0,0] op_sel_hi:[1,0]
    ds_write_b32 v203, v29 offset:12512
    v_pk_fma_f32 v[60:61], v[62:63], v[34:35], v[60:61] op_sel:[1,1,0] op_sel_hi:[0,1,1] neg_lo:[1,0,0]
    v_pk_fma_f32 v[68:69], v[70:71], v[36:37], v[68:69] op_sel:[1,1,0] op_sel_hi:[0,1,1] neg_lo:[1,0,0]
    v_cvt_pk_bf16_f32 v31, v60, v61
    v_cvt_pk_bf16_f32 v45, v68, v69
    ds_write_b32 v203, v31 offset:16864
    ds_write_b32 v203, v45 offset:20672
    v_pk_mul_f32 v[70:71], v[68:69], v[36:37] op_sel:[0,0] op_sel_hi:[1,0]
    v_pk_fma_f32 v[70:71], v[68:69], v[36:37], v[70:71] op_sel:[1,1,0] op_sel_hi:[0,1,1] neg_lo:[1,0,0]
    v_cvt_pk_bf16_f32 v44, v70, v71
    ds_write_b32 v203, v44 offset:21216
L_kg2:
    s_sub_u32 s14, s92, 64
    s_cmp_lt_u32 s14, 128
    s_cbranch_scc0 L_noscl
    s_waitcnt vmcnt(0)
    v_lshlrev_b32 v23, 16, v23
    v_mul_f32 v2, 0xbfb8aa3b, v23
    v_exp_f32 v2, v2
    v_and_b32 v3, 127, v0
    v_lshlrev_b32 v3, 1, v3
    v_add_f32 v2, 1.0, v2
    v_rcp_f32 v2, v2
    v_add_u32 v3, 143040, v3
    v_mul_f32 v2, v2, v23
    v_cvt_pk_bf16_f32 v2, v2, v2
    ds_write_b16 v3, v2
L_noscl:
    s_waitcnt lgkmcnt(0)
    s_barrier
    global_load_dwordx4 v[96:99], v222, s[48:49] sc1
    s_cmp_ge_u32 s4, 6
    s_cbranch_scc1 L_modmm
    ds_read_b128 v[32:35], v204 offset:0
    ds_read_b128 v[64:67], v205 offset:0
    ds_read_b128 v[36:39], v204 offset:64
    ds_read_b128 v[68:71], v205 offset:64
    ds_read_b128 v[40:43], v204 offset:128
    ds_read_b128 v[72:75], v205 offset:128
    ds_read_b128 v[44:47], v204 offset:192
    ds_read_b128 v[76:79], v205 offset:192
    ds_read_b128 v[48:51], v204 offset:256
    ds_read_b128 v[80:83], v205 offset:256
    ds_read_b128 v[52:55], v204 offset:320
    ds_read_b128 v[84:87], v205 offset:320
    ds_read_b128 v[56:59], v204 offset:384
    ds_read_b128 v[88:91], v205 offset:384
    ds_read_b128 v[60:63], v204 offset:448
    ds_read_b128 v[92:95], v205 offset:448
    v_and_b32 v104, 255, v0
    v_lshrrev_b32 v105, 8, v0
    v_mul_u32_u24 v106, 1312, v105
    v_add_u32 v106, 79936, v106
    v_lshlrev_b32 v107, 3, v104
    v_mul_u32_u24 v221, 16640, v105
    v_cvt_f32_u32 v108, v107
    v_lshl_add_u32 v221, v104, 4, v221
    v_add_u32 v221, 32, v221
    v_subrev_u32 v109, 34048, v106
    v_add_f32 v112, 0x3f800000, v108
    v_add_f32 v113, 0x40000000, v108
    v_add_f32 v114, 0x40400000, v108
    v_add_f32 v115, 0x40800000, v108
    v_add_f32 v116, 0x40a00000, v108
    v_add_f32 v117, 0x40c00000, v108
    v_add_f32 v118, 0x40e00000, v108
    v_add_f32 v119, 0x41000000, v108
    v_add_f32 v120, 0x41100000, v108
    v_add_f32 v121, 0x41200000, v108
    s_waitcnt lgkmcnt(12)
    v_mfma_f32_16x16x32_bf16 v[28:31], v[32:35], v[64:67], 0
    v_cvt_pk_bf16_f32 v110, v108, v112
    v_and_b32 v111, 0xffff, v110
    v_mfma_f32_16x16x32_bf16 v[24:27], v[36:39], v[68:71], 0
    v_lshl_add_u32 v210, v111, 1, v109
    v_lshrrev_b32 v111, 16, v110
    s_waitcnt lgkmcnt(8)
    v_mfma_f32_16x16x32_bf16 v[28:31], v[40:43], v[72:75], v[28:31]
    v_lshl_add_u32 v211, v111, 1, v109
    v_cvt_pk_bf16_f32 v110, v113, v114
    v_mfma_f32_16x16x32_bf16 v[24:27], v[44:47], v[76:79], v[24:27]
    v_and_b32 v111, 0xffff, v110
    v_lshl_add_u32 v212, v111, 1, v109
    s_waitcnt lgkmcnt(4)
    v_mfma_f32_16x16x32_bf16 v[28:31], v[48:51], v[80:83], v[28:31]
    v_lshrrev_b32 v111, 16, v110
    v_lshl_add_u32 v213, v111, 1, v109
    v_mfma_f32_16x16x32_bf16 v[24:27], v[52:55], v[84:87], v[24:27]
    v_cvt_pk_bf16_f32 v110, v115, v116
    v_and_b32 v111, 0xffff, v110
    s_waitcnt lgkmcnt(0)
    v_mfma_f32_16x16x32_bf16 v[28:31], v[56:59], v[88:91], v[28:31]
    v_lshl_add_u32 v214, v111, 1, v109
    v_lshrrev_b32 v111, 16, v110
    v_mfma_f32_16x16x32_bf16 v[24:27], v[60:63], v[92:95], v[24:27]
    v_lshl_add_u32 v215, v111, 1, v109
    v_cvt_pk_bf16_f32 v110, v117, v118
    v_and_b32 v111, 0xffff, v110
    v_lshl_add_u32 v216, v111, 1, v109
    v_lshrrev_b32 v111, 16, v110
    v_lshl_add_u32 v217, v111, 1, v109
    v_cvt_pk_bf16_f32 v110, v119, v120
    v_and_b32 v111, 0xffff, v110
    v_lshl_add_u32 v218, v111, 1, v109
    v_lshrrev_b32 v111, 16, v110
    v_lshl_add_u32 v219, v111, 1, v109
    v_cvt_pk_bf16_f32 v110, v121, v121
    v_and_b32 v111, 0xffff, v110
    v_lshl_add_u32 v220, v111, 1, v109
    v_pk_add_f32 v[28:29], v[28:29], v[24:25]
    v_pk_add_f32 v[30:31], v[30:31], v[26:27]
    v_cvt_pk_bf16_f32 v32, v28, v29
    v_cvt_pk_bf16_f32 v33, v30, v31
    ds_write_b16 v206, v32
    ds_write_b16_d16_hi v207, v32
    ds_write_b16 v208, v33
    ds_write_b16_d16_hi v209, v33
    s_branch L_mm_done
L_modmm:
    s_sub_u32 s14, s92, 64
    s_cmp_lt_u32 s14, 128
    s_cbranch_scc0 L_mm_skip
    s_sub_u32 s14, s4, 6
    v_lshrrev_b32 v3, 4, v1
    v_bfe_u32 v2, v1, 2, 2
    v_lshl_add_u32 v13, v3, 3, v2
    v_lshlrev_b32 v13, 7, v13
    v_and_b32 v14, 1, v1
    v_lshl_add_u32 v13, v14, 3, v13
    v_and_b32 v2, 2, v2
    v_and_b32 v14, 1, v3
    v_lshl_add_u32 v2, v14, 2, v2
    v_bfe_u32 v14, v1, 1, 1
    s_lshl_b32 s15, s14, 2
    v_add_u32 v14, s15, v14
    v_xor_b32 v24, v14, v2
    v_lshl_add_u32 v24, v24, 4, v13
    v_add_u32 v196, 82560, v24
    v_add_u32 v14, 2, v14
    v_xor_b32 v25, v14, v2
    v_lshl_add_u32 v25, v25, 4, v13
    v_add_u32 v197, 82560, v25
    v_lshlrev_b32 v14, 4, v3
    v_add_u32 v198, 143040, v14
    s_sub_u32 s14, s4, 6
    s_and_b32 s15, s92, 3
    s_mul_i32 s15, s15, 24576
    s_lshr_b32 s52, s92, 2
    s_lshl_b32 s52, s52, 9
    s_add_u32 s15, s15, s52
    s_lshl_b32 s14, s14, 8
    s_add_u32 s15, s15, s14
    s_add_u32 s15, s15, 7340032
    v_lshl_add_u32 v199, v1, 4, s15
    ds_read_b128 v[64:67], v198 offset:0
    ds_read_b64_tr_b16 v[32:33], v196 offset:0
    ds_read_b64_tr_b16 v[34:35], v196 offset:512
    ds_read_b64_tr_b16 v[36:37], v197 offset:0
    ds_read_b64_tr_b16 v[38:39], v197 offset:512
    ds_read_b128 v[68:71], v198 offset:64
    ds_read_b64_tr_b16 v[40:41], v196 offset:4096
    ds_read_b64_tr_b16 v[42:43], v196 offset:4608
    ds_read_b64_tr_b16 v[44:45], v197 offset:4096
    ds_read_b64_tr_b16 v[46:47], v197 offset:4608
    ds_read_b128 v[72:75], v198 offset:128
    ds_read_b64_tr_b16 v[48:49], v196 offset:8192
    ds_read_b64_tr_b16 v[50:51], v196 offset:8704
    ds_read_b64_tr_b16 v[52:53], v197 offset:8192
    ds_read_b64_tr_b16 v[54:55], v197 offset:8704
    ds_read_b128 v[76:79], v198 offset:192
    ds_read_b64_tr_b16 v[56:57], v196 offset:12288
    ds_read_b64_tr_b16 v[58:59], v196 offset:12800
    ds_read_b64_tr_b16 v[60:61], v197 offset:12288
    ds_read_b64_tr_b16 v[62:63], v197 offset:12800
    v_lshlrev_b32 v3, 3, v1
    v_add_u32 v13, 4, v3
    s_waitcnt lgkmcnt(14)
    v_mfma_f32_16x16x32_bf16 v[80:83], v[64:67], v[32:35], 0
    v_mfma_f32_16x16x32_bf16 v[84:87], v[64:67], v[36:39], 0
    s_waitcnt lgkmcnt(10)
    v_mfma_f32_16x16x32_bf16 v[80:83], v[68:71], v[40:43], v[80:83]
    v_mfma_f32_16x16x32_bf16 v[84:87], v[68:71], v[44:47], v[84:87]
    s_waitcnt lgkmcnt(5)
    v_mfma_f32_16x16x32_bf16 v[80:83], v[72:75], v[48:51], v[80:83]
    v_mfma_f32_16x16x32_bf16 v[84:87], v[72:75], v[52:55], v[84:87]
    s_waitcnt lgkmcnt(0)
    v_mfma_f32_16x16x32_bf16 v[80:83], v[76:79], v[56:59], v[80:83]
    v_mfma_f32_16x16x32_bf16 v[84:87], v[76:79], v[60:63], v[84:87]
    s_nop 7
    v_permlane16_swap_b32 v80, v84
    s_nop 1
    ds_bpermute_b32 v32, v3, v80
    ds_bpermute_b32 v33, v13, v80
    v_mov_b32 v34, s5
    v_mov_b32 v35, s5
    s_mov_b64 s[52:53], exec
    s_mov_b64 exec, 0xffff
    s_waitcnt lgkmcnt(0)
    global_store_dwordx4 v199, v[32:35], s[48:49] sc1
    s_mov_b64 exec, s[52:53]
L_mm_skip:
    v_and_b32 v104, 255, v0
    v_lshrrev_b32 v105, 8, v0
    v_mul_u32_u24 v106, 1312, v105
    v_add_u32 v106, 79936, v106
    v_lshlrev_b32 v107, 3, v104
    v_mul_u32_u24 v221, 16640, v105
    v_cvt_f32_u32 v108, v107
    v_lshl_add_u32 v221, v104, 4, v221
    v_add_u32 v221, 32, v221
    v_subrev_u32 v109, 34048, v106
    v_add_f32 v112, 0x3f800000, v108
    v_add_f32 v113, 0x40000000, v108
    v_add_f32 v114, 0x40400000, v108
    v_add_f32 v115, 0x40800000, v108
    v_add_f32 v116, 0x40a00000, v108
    v_add_f32 v117, 0x40c00000, v108
    v_add_f32 v118, 0x40e00000, v108
    v_add_f32 v119, 0x41000000, v108
    v_add_f32 v120, 0x41100000, v108
    v_add_f32 v121, 0x41200000, v108
    v_cvt_pk_bf16_f32 v110, v108, v112
    v_and_b32 v111, 0xffff, v110
    v_lshl_add_u32 v210, v111, 1, v109
    v_lshrrev_b32 v111, 16, v110
    v_lshl_add_u32 v211, v111, 1, v109
    v_cvt_pk_bf16_f32 v110, v113, v114
    v_and_b32 v111, 0xffff, v110
    v_lshl_add_u32 v212, v111, 1, v109
    v_lshrrev_b32 v111, 16, v110
    v_lshl_add_u32 v213, v111, 1, v109
    v_cvt_pk_bf16_f32 v110, v115, v116
    v_and_b32 v111, 0xffff, v110
    v_lshl_add_u32 v214, v111, 1, v109
    v_lshrrev_b32 v111, 16, v110
    v_lshl_add_u32 v215, v111, 1, v109
    v_cvt_pk_bf16_f32 v110, v117, v118
    v_and_b32 v111, 0xffff, v110
    v_lshl_add_u32 v216, v111, 1, v109
    v_lshrrev_b32 v111, 16, v110
    v_lshl_add_u32 v217, v111, 1, v109
    v_cvt_pk_bf16_f32 v110, v119, v120
    v_and_b32 v111, 0xffff, v110
    v_lshl_add_u32 v218, v111, 1, v109
    v_lshrrev_b32 v111, 16, v110
    v_lshl_add_u32 v219, v111, 1, v109
    v_cvt_pk_bf16_f32 v110, v121, v121
    v_and_b32 v111, 0xffff, v110
    v_lshl_add_u32 v220, v111, 1, v109
L_mm_done:
    s_and_b32 s14, s4, 3
    s_cmp_eq_u32 s14, 0
    s_cbranch_scc0 L_nosmall
    v_lshl_add_u32 v110, v107, 1, v106
    v_cmp_gt_u32 vcc, 32, v104
    s_nop 3
    s_and_saveexec_b64 s[52:53], vcc
    v_add_u32 v210, 0, v110
    v_add_u32 v211, 2, v110
    v_add_u32 v212, 4, v110
    v_add_u32 v213, 6, v110
    v_add_u32 v214, 8, v110
    v_add_u32 v215, 10, v110
    v_add_u32 v216, 12, v110
    v_add_u32 v217, 14, v110
    v_cmp_gt_u32 vcc, 31, v104
    s_nop 3
    s_and_b64 exec, exec, vcc
    v_add_u32 v218, 16, v110
    v_add_u32 v219, 18, v110
    v_add_u32 v220, 20, v110
    s_mov_b64 exec, s[52:53]
L_nosmall:
    s_waitcnt lgkmcnt(0)
    s_barrier
    global_load_dwordx4 v[100:103], v255, s[48:49] sc1
    ds_read_u16 v32, v210
    ds_read_u16 v33, v211
    ds_read_u16 v34, v212
    ds_read_u16 v35, v213
    ds_read_u16 v36, v214
    ds_read_u16 v37, v215
    ds_read_u16 v38, v216
    ds_read_u16 v39, v217
    ds_read_u16 v40, v218
    ds_read_u16 v41, v219
    ds_read_u16 v42, v220
    s_waitcnt lgkmcnt(0)
    v_lshl_or_b32 v48, v33, 16, v32
    v_lshl_or_b32 v49, v35, 16, v34
    v_lshl_or_b32 v50, v37, 16, v36
    v_lshl_or_b32 v51, v39, 16, v38
    v_lshl_or_b32 v52, v34, 16, v33
    v_lshl_or_b32 v53, v36, 16, v35
    v_lshl_or_b32 v54, v38, 16, v37
    v_lshl_or_b32 v55, v40, 16, v39
    v_lshl_or_b32 v56, v35, 16, v34
    v_lshl_or_b32 v57, v37, 16, v36
    v_lshl_or_b32 v58, v39, 16, v38
    v_lshl_or_b32 v59, v41, 16, v40
    v_lshl_or_b32 v60, v36, 16, v35
    v_lshl_or_b32 v61, v38, 16, v37
    v_lshl_or_b32 v62, v40, 16, v39
    v_lshl_or_b32 v63, v42, 16, v41
    ds_write_b128 v221, v[48:51] offset:0
    ds_write_b128 v221, v[52:55] offset:4160
    ds_write_b128 v221, v[56:59] offset:8320
    ds_write_b128 v221, v[60:63] offset:12480
    s_and_b32 s14, s4, 3
    s_cmp_eq_u32 s14, 0
    s_cbranch_scc0 L_noneg
    s_mov_b64 s[52:53], exec
    s_mov_b64 exec, 1
    v_subrev_u32 v2, 32, v221
    v_mov_b32 v40, 0
    v_mov_b32 v41, 0
    v_mov_b32 v42, 0
    v_mov_b32 v43, 0
    ds_write_b128 v2, v[40:43]
    ds_write_b128 v2, v[40:43] offset:16
    ds_write_b128 v2, v[40:43] offset:4160
    ds_write_b128 v2, v[40:43] offset:8320
    ds_write_b128 v2, v[40:43] offset:12480
    v_lshlrev_b32 v47, 16, v32
    v_mov_b32 v44, 0
    v_mov_b32 v45, 0
    v_mov_b32 v46, 0
    ds_write_b128 v2, v[44:47] offset:4176
    v_mov_b32 v43, v48
    ds_write_b128 v2, v[40:43] offset:8336
    v_mov_b32 v46, v47
    v_mov_b32 v47, v52
    s_nop 0
    ds_write_b128 v2, v[44:47] offset:12496
    s_mov_b64 exec, s[52:53]
L_noneg:
    v_and_b32 v24, 255, v0
    v_lshrrev_b32 v2, 5, v24
    s_lshl_b32 s14, s30, 5
    v_add_u32 v2, s14, v2
    v_and_b32 v3, 31, v24
    v_min_u32 v3, 22, v3
    s_mul_i32 s14, s31, 352
    v_lshl_add_u32 v13, v3, 4, s14
    v_min_u32 v13, 2736, v13
    v_and_b32 v14, 511, v2
    v_mul_u32_u24 v14, 2752, v14
    v_add_u32 v252, v14, v13
    v_lshrrev_b32 v2, 3, v24
    s_mul_i32 s14, s30, 43
    v_add_u32 v3, s14, v2
    v_lshlrev_b32 v3, 10, v3
    v_and_b32 v13, 7, v24
    v_lshl_add_u32 v3, v13, 4, v3
    s_lshl_b32 s14, s31, 7
    v_add_u32 v253, s14, v3
    v_min_u32 v2, 10, v2
    s_mul_i32 s14, s30, 43
    s_add_u32 s14, s14, 32
    v_add_u32 v2, s14, v2
    v_lshlrev_b32 v2, 10, v2
    v_lshl_add_u32 v2, v13, 4, v2
    s_lshl_b32 s14, s31, 7
    v_add_u32 v254, s14, v2
    v_lshrrev_b32 v3, 1, v0
    v_and_b32 v14, 1, v0
    v_mul_u32_u24 v26, 4608, v14
    v_lshl_add_u32 v26, v3, 4, v26
    v_add_u32 v223, 62528, v26
    s_lshr_b32 s54, s4, 1
    s_and_b32 s54, s54, 1
    s_and_b32 s55, s4, 1
    v_and_b32 v13, 15, v1
    v_add_u32 v27, 1, v13
    v_and_b32 v28, 3, v27
    v_lshrrev_b32 v27, 2, v27
    v_mul_u32_u24 v28, 4160, v28
    v_lshl_add_u32 v28, v27, 3, v28
    v_lshrrev_b32 v29, 5, v1
    v_bfe_u32 v30, v1, 4, 1
    v_lshlrev_b32 v31, 1, v29
    v_sub_u32 v31, v31, v30
    v_lshlrev_b32 v31, 4, v31
    s_mul_i32 s14, s54, 16640
    s_lshl_b32 s15, s55, 8
    s_add_u32 s14, s14, s15
    s_add_u32 s14, s14, 16
    v_add3_u32 v224, v28, v31, s14
    v_sub_u32 v31, v13, v29
    v_lshlrev_b32 v31, 5, v31
    v_lshl_add_u32 v31, v30, 4, v31
    s_mul_i32 s14, s54, 4608
    s_add_u32 s14, s14, 62336
    s_sub_u32 s14, s14, s15
    v_add_u32 v225, s14, v31
    v_cmp_eq_u32 s[52:53], 1, v14
    s_mov_b32 s14, 0
    s_waitcnt vmcnt(0)
    v_mov_b64 v[32:33], v[96:97]
    v_mov_b64 v[34:35], v[98:99]
    v_mov_b64 v[28:29], v[100:101]
    v_mov_b64 v[30:31], v[102:103]
    s_branch L_e1chk
L_e1poll:
    global_load_dwordx4 v[32:35], v222, s[48:49] sc1
    global_load_dwordx4 v[28:31], v255, s[48:49] sc1
    s_add_u32 s14, s14, 1
    s_waitcnt vmcnt(0)
L_e1chk:
    v_xor_b32 v36, s8, v32
    v_xor_b32 v37, s9, v33
    v_xor_b32 v38, s10, v34
    v_xor_b32 v39, s11, v35
    v_or3_b32 v36, v36, v37, v38
    v_or_b32 v36, v36, v39
    v_and_b32 v36, 0x00070007, v36
    v_xor_b32 v37, s5, v30
    v_or_b32 v36, v36, v37
    v_cmp_ne_u32 vcc, 0, v36
    s_cbranch_vccnz L_e1retry
L_e1got:
    v_add_f32_dpp v28, v28, v28 quad_perm:[1,0,3,2] row_mask:0xf bank_mask:0xf
    v_add_f32_dpp v29, v29, v29 quad_perm:[1,0,3,2] row_mask:0xf bank_mask:0xf
    v_and_b32 v32, v32, v226
    v_add_f32_dpp v28, v28, v28 quad_perm:[2,3,0,1] row_mask:0xf bank_mask:0xf
    v_add_f32_dpp v29, v29, v29 quad_perm:[2,3,0,1] row_mask:0xf bank_mask:0xf
    v_and_b32 v33, v33, v226
    v_and_b32 v34, v34, v226
    v_cvt_pk_bf16_f32 v28, v28, v29
    v_and_b32 v35, v35, v226
    v_readlane_b32 s6, v28, 0
    v_readlane_b32 s7, v28, 4
    s_nop 2
    s_lshl_b32 s14, s6, 16
    s_and_b32 s6, s6, 0xffff0000
    s_lshl_b32 s15, s7, 16
    s_and_b32 s7, s7, 0xffff0000
    v_mov_b32 v25, s14
    v_mov_b32 v26, s6
    v_mov_b32 v24, s15
    v_mov_b32 v27, s7
    v_cndmask_b32 v25, v25, v26, s[52:53]
    v_cndmask_b32 v24, v24, v27, s[52:53]
    v_add_f32 v24, 1.0, v24
    v_cvt_pk_bf16_f32 v24, v24, v24
    v_and_b32 v24, 0xffff0000, v24
    v_fma_mix_f32 v40, v32, v24, v25 op_sel:[0,0,0] op_sel_hi:[1,0,0]
    v_fma_mix_f32 v41, v32, v24, v25 op_sel:[1,0,0] op_sel_hi:[1,0,0]
    v_fma_mix_f32 v42, v33, v24, v25 op_sel:[0,0,0] op_sel_hi:[1,0,0]
    v_fma_mix_f32 v43, v33, v24, v25 op_sel:[1,0,0] op_sel_hi:[1,0,0]
    v_fma_mix_f32 v44, v34, v24, v25 op_sel:[0,0,0] op_sel_hi:[1,0,0]
    v_fma_mix_f32 v45, v34, v24, v25 op_sel:[1,0,0] op_sel_hi:[1,0,0]
    v_fma_mix_f32 v46, v35, v24, v25 op_sel:[0,0,0] op_sel_hi:[1,0,0]
    v_fma_mix_f32 v47, v35, v24, v25 op_sel:[1,0,0] op_sel_hi:[1,0,0]
    v_cvt_pk_bf16_f32 v32, v47, v46
    v_cvt_pk_bf16_f32 v33, v45, v44
    v_cvt_pk_bf16_f32 v34, v43, v42
    v_cvt_pk_bf16_f32 v35, v41, v40
    ds_write_b128 v223, v[32:35]
    s_waitcnt lgkmcnt(0)
    s_barrier
    s_setprio 0
    s_cmp_ge_u32 s4, 4
    s_cbranch_scc1 L_wpref
    ds_read_b128 v[128:131], v225 offset:192
    ds_read_b64 v[96:97], v224 offset:0
    ds_read_b64 v[98:99], v224 offset:8
    ds_read_b128 v[132:135], v225 offset:704
    ds_read_b64 v[100:101], v224 offset:512
    ds_read_b64 v[102:103], v224 offset:520
    ds_read_b128 v[136:139], v225 offset:1216
    ds_read_b64 v[104:105], v224 offset:1024
    ds_read_b64 v[106:107], v224 offset:1032
    ds_read_b128 v[140:143], v225 offset:1728
    ds_read_b64 v[108:109], v224 offset:1536
    ds_read_b64 v[110:111], v224 offset:1544
    ds_read_b128 v[144:147], v225 offset:2240
    ds_read_b64 v[112:113], v224 offset:2048
    ds_read_b64 v[114:115], v224 offset:2056
    ds_read_b128 v[148:151], v225 offset:2752
    ds_read_b64 v[116:117], v224 offset:2560
    ds_read_b64 v[118:119], v224 offset:2568
    ds_read_b128 v[152:155], v225 offset:3264
    ds_read_b64 v[120:121], v224 offset:3072
    ds_read_b64 v[122:123], v224 offset:3080
    ds_read_b128 v[156:159], v225 offset:3776
    ds_read_b64 v[124:125], v224 offset:3584
    ds_read_b64 v[126:127], v224 offset:3592
    s_waitcnt lgkmcnt(14)
    v_mfma_f32_16x16x32_bf16 v[64:67], v[96:99], v[128:131], 0
    v_mfma_f32_16x16x32_bf16 v[68:71], v[100:103], v[128:131], 0
    v_mfma_f32_16x16x32_bf16 v[68:71], v[96:99], v[132:135], v[68:71]
    v_mfma_f32_16x16x32_bf16 v[72:75], v[104:107], v[128:131], 0
    v_mfma_f32_16x16x32_bf16 v[72:75], v[100:103], v[132:135], v[72:75]
    v_mfma_f32_16x16x32_bf16 v[72:75], v[96:99], v[136:139], v[72:75]
    s_waitcnt lgkmcnt(12)
    v_mfma_f32_16x16x32_bf16 v[76:79], v[108:111], v[128:131], 0
    ds_read_b128 v[192:195], v225 offset:128
    v_mfma_f32_16x16x32_bf16 v[76:79], v[104:107], v[132:135], v[76:79]
    ds_read_b64 v[160:161], v224 offset:64
    v_mfma_f32_16x16x32_bf16 v[76:79], v[100:103], v[136:139], v[76:79]
    ds_read_b64 v[162:163], v224 offset:72
    v_mfma_f32_16x16x32_bf16 v[76:79], v[96:99], v[140:143], v[76:79]
    ds_read_b128 v[196:199], v225 offset:640
    s_waitcnt lgkmcnt(13)
    v_mfma_f32_16x16x32_bf16 v[80:83], v[112:115], v[128:131], 0
    ds_read_b64 v[164:165], v224 offset:576
    v_mfma_f32_16x16x32_bf16 v[80:83], v[108:111], v[132:135], v[80:83]
    ds_read_b64 v[166:167], v224 offset:584
    v_mfma_f32_16x16x32_bf16 v[80:83], v[104:107], v[136:139], v[80:83]
    ds_read_b128 v[200:203], v225 offset:1152
    v_mfma_f32_16x16x32_bf16 v[80:83], v[100:103], v[140:143], v[80:83]
    ds_read_b64 v[168:169], v224 offset:1088
    v_mfma_f32_16x16x32_bf16 v[80:83], v[96:99], v[144:147], v[80:83]
    ds_read_b64 v[170:171], v224 offset:1096
    v_mfma_f32_16x16x32_bf16 v[84:87], v[116:119], v[128:131], 0
    ds_read_b128 v[204:207], v225 offset:1664
    v_mfma_f32_16x16x32_bf16 v[84:87], v[112:115], v[132:135], v[84:87]
    ds_read_b64 v[172:173], v224 offset:1600
    v_mfma_f32_16x16x32_bf16 v[84:87], v[108:111], v[136:139], v[84:87]
    ds_read_b64 v[174:175], v224 offset:1608
    v_mfma_f32_16x16x32_bf16 v[84:87], v[104:107], v[140:143], v[84:87]
    ds_read_b128 v[208:211], v225 offset:2176
    v_mfma_f32_16x16x32_bf16 v[84:87], v[100:103], v[144:147], v[84:87]
    ds_read_b64 v[176:177], v224 offset:2112
    v_mfma_f32_16x16x32_bf16 v[84:87], v[96:99], v[148:151], v[84:87]
    ds_read_b64 v[178:179], v224 offset:2120
    v_mfma_f32_16x16x32_bf16 v[88:91], v[120:123], v[128:131], 0
    ds_read_b128 v[212:215], v225 offset:2688
    v_mfma_f32_16x16x32_bf16 v[88:91], v[116:119], v[132:135], v[88:91]
    ds_read_b64 v[180:181], v224 offset:2624
    v_mfma_f32_16x16x32_bf16 v[88:91], v[112:115], v[136:139], v[88:91]
    ds_read_b64 v[182:183], v224 offset:2632
    v_mfma_f32_16x16x32_bf16 v[88:91], v[108:111], v[140:143], v[88:91]
    ds_read_b128 v[216:219], v225 offset:3200
    v_mfma_f32_16x16x32_bf16 v[88:91], v[104:107], v[144:147], v[88:91]
    ds_read_b64 v[184:185], v224 offset:3136
    v_mfma_f32_16x16x32_bf16 v[88:91], v[100:103], v[148:151], v[88:91]
    ds_read_b64 v[186:187], v224 offset:3144
    v_mfma_f32_16x16x32_bf16 v[88:91], v[96:99], v[152:155], v[88:91]
    ds_read_b128 v[220:223], v225 offset:3712
    v_mfma_f32_16x16x32_bf16 v[92:95], v[124:127], v[128:131], 0
    ds_read_b64 v[188:189], v224 offset:3648
    v_mfma_f32_16x16x32_bf16 v[92:95], v[120:123], v[132:135], v[92:95]
    ds_read_b64 v[190:191], v224 offset:3656
    v_mfma_f32_16x16x32_bf16 v[92:95], v[116:119], v[136:139], v[92:95]
    v_mfma_f32_16x16x32_bf16 v[92:95], v[112:115], v[140:143], v[92:95]
    v_mfma_f32_16x16x32_bf16 v[92:95], v[108:111], v[144:147], v[92:95]
    v_mfma_f32_16x16x32_bf16 v[92:95], v[104:107], v[148:151], v[92:95]
    v_mfma_f32_16x16x32_bf16 v[92:95], v[100:103], v[152:155], v[92:95]
    v_mfma_f32_16x16x32_bf16 v[92:95], v[96:99], v[156:159], v[92:95]
    s_waitcnt lgkmcnt(0)
    v_mfma_f32_16x16x32_bf16 v[64:67], v[160:163], v[192:195], v[64:67]
    ds_read_b128 v[128:131], v225 offset:64
    v_mfma_f32_16x16x32_bf16 v[68:71], v[164:167], v[192:195], v[68:71]
    ds_read_b64 v[96:97], v224 offset:128
    v_mfma_f32_16x16x32_bf16 v[68:71], v[160:163], v[196:199], v[68:71]
    ds_read_b64 v[98:99], v224 offset:136
    v_mfma_f32_16x16x32_bf16 v[72:75], v[168:171], v[192:195], v[72:75]
    ds_read_b128 v[132:135], v225 offset:576
    v_mfma_f32_16x16x32_bf16 v[72:75], v[164:167], v[196:199], v[72:75]
    ds_read_b64 v[100:101], v224 offset:640
    v_mfma_f32_16x16x32_bf16 v[72:75], v[160:163], v[200:203], v[72:75]
    ds_read_b64 v[102:103], v224 offset:648
    v_mfma_f32_16x16x32_bf16 v[76:79], v[172:175], v[192:195], v[76:79]
    ds_read_b128 v[136:139], v225 offset:1088
    v_mfma_f32_16x16x32_bf16 v[76:79], v[168:171], v[196:199], v[76:79]
    ds_read_b64 v[104:105], v224 offset:1152
    v_mfma_f32_16x16x32_bf16 v[76:79], v[164:167], v[200:203], v[76:79]
    ds_read_b64 v[106:107], v224 offset:1160
    v_mfma_f32_16x16x32_bf16 v[76:79], v[160:163], v[204:207], v[76:79]
    ds_read_b128 v[140:143], v225 offset:1600
    v_mfma_f32_16x16x32_bf16 v[80:83], v[176:179], v[192:195], v[80:83]
    ds_read_b64 v[108:109], v224 offset:1664
    v_mfma_f32_16x16x32_bf16 v[80:83], v[172:175], v[196:199], v[80:83]
    ds_read_b64 v[110:111], v224 offset:1672
    v_mfma_f32_16x16x32_bf16 v[80:83], v[168:171], v[200:203], v[80:83]
    ds_read_b128 v[144:147], v225 offset:2112
    v_mfma_f32_16x16x32_bf16 v[80:83], v[164:167], v[204:207], v[80:83]
    ds_read_b64 v[112:113], v224 offset:2176
    v_mfma_f32_16x16x32_bf16 v[80:83], v[160:163], v[208:211], v[80:83]
    ds_read_b64 v[114:115], v224 offset:2184
    v_mfma_f32_16x16x32_bf16 v[84:87], v[180:183], v[192:195], v[84:87]
    ds_read_b128 v[148:151], v225 offset:2624
    v_mfma_f32_16x16x32_bf16 v[84:87], v[176:179], v[196:199], v[84:87]
    ds_read_b64 v[116:117], v224 offset:2688
    v_mfma_f32_16x16x32_bf16 v[84:87], v[172:175], v[200:203], v[84:87]
    ds_read_b64 v[118:119], v224 offset:2696
    v_mfma_f32_16x16x32_bf16 v[84:87], v[168:171], v[204:207], v[84:87]
    ds_read_b128 v[152:155], v225 offset:3136
    v_mfma_f32_16x16x32_bf16 v[84:87], v[164:167], v[208:211], v[84:87]
    ds_read_b64 v[120:121], v224 offset:3200
    v_mfma_f32_16x16x32_bf16 v[84:87], v[160:163], v[212:215], v[84:87]
    ds_read_b64 v[122:123], v224 offset:3208
    v_mfma_f32_16x16x32_bf16 v[88:91], v[184:187], v[192:195], v[88:91]
    ds_read_b128 v[156:159], v225 offset:3648
    v_mfma_f32_16x16x32_bf16 v[88:91], v[180:183], v[196:199], v[88:91]
    ds_read_b64 v[124:125], v224 offset:3712
    v_mfma_f32_16x16x32_bf16 v[88:91], v[176:179], v[200:203], v[88:91]
    ds_read_b64 v[126:127], v224 offset:3720
    v_mfma_f32_16x16x32_bf16 v[88:91], v[172:175], v[204:207], v[88:91]
    s_cmp_lt_u32 s30, 16
    v_mfma_f32_16x16x32_bf16 v[88:91], v[168:171], v[208:211], v[88:91]
    s_cselect_b32 s6, s34, s36
    v_mfma_f32_16x16x32_bf16 v[88:91], v[164:167], v[212:215], v[88:91]
    s_cselect_b32 s7, s35, s37
    v_mfma_f32_16x16x32_bf16 v[88:91], v[160:163], v[216:219], v[88:91]
    v_add_u32 v13, 22016, v252
    v_mfma_f32_16x16x32_bf16 v[92:95], v[188:191], v[192:195], v[92:95]
    v_add_u32 v14, 44032, v252
    v_mfma_f32_16x16x32_bf16 v[92:95], v[184:187], v[196:199], v[92:95]
    v_add_u32 v2, 66048, v252
    v_mfma_f32_16x16x32_bf16 v[92:95], v[180:183], v[200:203], v[92:95]
    global_load_dwordx4 v[236:239], v252, s[6:7]
    v_mfma_f32_16x16x32_bf16 v[92:95], v[176:179], v[204:207], v[92:95]
    global_load_dwordx4 v[236:239], v13, s[6:7]
    v_mfma_f32_16x16x32_bf16 v[92:95], v[172:175], v[208:211], v[92:95]
    global_load_dwordx4 v[236:239], v14, s[6:7]
    v_mfma_f32_16x16x32_bf16 v[92:95], v[168:171], v[212:215], v[92:95]
    global_load_dwordx4 v[236:239], v2, s[6:7]
    v_mfma_f32_16x16x32_bf16 v[92:95], v[164:167], v[216:219], v[92:95]
    global_load_dwordx4 v[240:243], v253, s[38:39]
    v_mfma_f32_16x16x32_bf16 v[92:95], v[160:163], v[220:223], v[92:95]
    global_load_dwordx4 v[240:243], v254, s[38:39]
    s_waitcnt lgkmcnt(0)
    v_mfma_f32_16x16x32_bf16 v[64:67], v[96:99], v[128:131], v[64:67]
    ds_read_b128 v[192:195], v225 offset:0
    v_mfma_f32_16x16x32_bf16 v[68:71], v[100:103], v[128:131], v[68:71]
    ds_read_b64 v[160:161], v224 offset:192
    v_mfma_f32_16x16x32_bf16 v[68:71], v[96:99], v[132:135], v[68:71]
    ds_read_b64 v[162:163], v224 offset:200
    v_mfma_f32_16x16x32_bf16 v[72:75], v[104:107], v[128:131], v[72:75]
    ds_read_b128 v[196:199], v225 offset:512
    v_mfma_f32_16x16x32_bf16 v[72:75], v[100:103], v[132:135], v[72:75]
    ds_read_b64 v[164:165], v224 offset:704
    v_mfma_f32_16x16x32_bf16 v[72:75], v[96:99], v[136:139], v[72:75]
    ds_read_b64 v[166:167], v224 offset:712
    v_mfma_f32_16x16x32_bf16 v[76:79], v[108:111], v[128:131], v[76:79]
    ds_read_b128 v[200:203], v225 offset:1024
    v_mfma_f32_16x16x32_bf16 v[76:79], v[104:107], v[132:135], v[76:79]
    ds_read_b64 v[168:169], v224 offset:1216
    v_mfma_f32_16x16x32_bf16 v[76:79], v[100:103], v[136:139], v[76:79]
    ds_read_b64 v[170:171], v224 offset:1224
    v_mfma_f32_16x16x32_bf16 v[76:79], v[96:99], v[140:143], v[76:79]
    ds_read_b128 v[204:207], v225 offset:1536
    v_mfma_f32_16x16x32_bf16 v[80:83], v[112:115], v[128:131], v[80:83]
    ds_read_b64 v[172:173], v224 offset:1728
    v_mfma_f32_16x16x32_bf16 v[80:83], v[108:111], v[132:135], v[80:83]
    ds_read_b64 v[174:175], v224 offset:1736
    v_mfma_f32_16x16x32_bf16 v[80:83], v[104:107], v[136:139], v[80:83]
    ds_read_b128 v[208:211], v225 offset:2048
    v_mfma_f32_16x16x32_bf16 v[80:83], v[100:103], v[140:143], v[80:83]
    ds_read_b64 v[176:177], v224 offset:2240
    v_mfma_f32_16x16x32_bf16 v[80:83], v[96:99], v[144:147], v[80:83]
    ds_read_b64 v[178:179], v224 offset:2248
    v_mfma_f32_16x16x32_bf16 v[84:87], v[116:119], v[128:131], v[84:87]
    ds_read_b128 v[212:215], v225 offset:2560
    v_mfma_f32_16x16x32_bf16 v[84:87], v[112:115], v[132:135], v[84:87]
    ds_read_b64 v[180:181], v224 offset:2752
    v_mfma_f32_16x16x32_bf16 v[84:87], v[108:111], v[136:139], v[84:87]
    ds_read_b64 v[182:183], v224 offset:2760
    v_mfma_f32_16x16x32_bf16 v[84:87], v[104:107], v[140:143], v[84:87]
    ds_read_b128 v[216:219], v225 offset:3072
    v_mfma_f32_16x16x32_bf16 v[84:87], v[100:103], v[144:147], v[84:87]
    ds_read_b64 v[184:185], v224 offset:3264
    v_mfma_f32_16x16x32_bf16 v[84:87], v[96:99], v[148:151], v[84:87]
    ds_read_b64 v[186:187], v224 offset:3272
    v_mfma_f32_16x16x32_bf16 v[88:91], v[120:123], v[128:131], v[88:91]
    ds_read_b128 v[220:223], v225 offset:3584
    v_mfma_f32_16x16x32_bf16 v[88:91], v[116:119], v[132:135], v[88:91]
    ds_read_b64 v[188:189], v224 offset:3776
    v_mfma_f32_16x16x32_bf16 v[88:91], v[112:115], v[136:139], v[88:91]
    ds_read_b64 v[190:191], v224 offset:3784
    v_mfma_f32_16x16x32_bf16 v[88:91], v[108:111], v[140:143], v[88:91]
    s_lshl_b32 s14, s4, 12
    v_mfma_f32_16x16x32_bf16 v[88:91], v[104:107], v[144:147], v[88:91]
    s_add_u32 s14, s14, 33280
    v_mfma_f32_16x16x32_bf16 v[88:91], v[100:103], v[148:151], v[88:91]
    v_lshl_add_u32 v56, v1, 4, s14
    v_mfma_f32_16x16x32_bf16 v[88:91], v[96:99], v[152:155], v[88:91]
    s_xor_b32 s14, s4, 1
    v_mfma_f32_16x16x32_bf16 v[92:95], v[124:127], v[128:131], v[92:95]
    s_lshl_b32 s14, s14, 12
    v_mfma_f32_16x16x32_bf16 v[92:95], v[120:123], v[132:135], v[92:95]
    s_add_u32 s14, s14, 33280
    v_mfma_f32_16x16x32_bf16 v[92:95], v[116:119], v[136:139], v[92:95]
    v_lshl_add_u32 v57, v1, 4, s14
    v_mfma_f32_16x16x32_bf16 v[92:95], v[112:115], v[140:143], v[92:95]
    v_and_b32 v14, 15, v1
    v_mfma_f32_16x16x32_bf16 v[92:95], v[108:111], v[144:147], v[92:95]
    v_lshrrev_b32 v27, 4, v1
    v_mfma_f32_16x16x32_bf16 v[92:95], v[104:107], v[148:151], v[92:95]
    v_lshlrev_b32 v14, 5, v14
    v_mfma_f32_16x16x32_bf16 v[92:95], v[100:103], v[152:155], v[92:95]
    v_lshrrev_b32 v28, 1, v27
    v_mfma_f32_16x16x32_bf16 v[92:95], v[96:99], v[156:159], v[92:95]
    v_lshl_add_u32 v28, v28, 4, v14
    s_waitcnt lgkmcnt(0)
    v_mfma_f32_16x16x32_bf16 v[64:67], v[160:163], v[192:195], v[64:67]
    v_and_b32 v29, 1, v27
    v_sub_u32 v29, 1, v29
    v_mfma_f32_16x16x32_bf16 v[68:71], v[164:167], v[192:195], v[68:71]
    v_lshl_add_u32 v28, v29, 3, v28
    s_mul_i32 s14, s54, 4608
    v_mfma_f32_16x16x32_bf16 v[68:71], v[160:163], v[196:199], v[68:71]
    s_lshl_b32 s15, s55, 9
    s_add_u32 s14, s14, s15
    v_mfma_f32_16x16x32_bf16 v[72:75], v[168:171], v[192:195], v[72:75]
    s_add_u32 s14, s14, 62528
    v_add_u32 v58, s14, v28
    v_mfma_f32_16x16x32_bf16 v[72:75], v[164:167], v[196:199], v[72:75]
    v_lshl_add_u32 v29, v27, 3, v14
    s_lshl_b32 s14, s54, 12
    v_mfma_f32_16x16x32_bf16 v[72:75], v[160:163], v[200:203], v[72:75]
    s_add_u32 s14, s14, s15
    s_add_u32 s14, s14, 49664
    v_mfma_f32_16x16x32_bf16 v[76:79], v[172:175], v[192:195], v[76:79]
    v_add_u32 v59, s14, v29
    s_lshl_b32 s14, s54, 4
    v_mfma_f32_16x16x32_bf16 v[76:79], v[168:171], v[196:199], v[76:79]
    s_lshr_b32 s14, s13, s14
    s_and_b32 s14, s14, 0xffff
    v_mfma_f32_16x16x32_bf16 v[76:79], v[164:167], v[200:203], v[76:79]
    s_lshl_b32 s15, s14, 16
    v_mov_b32 v62, s14
    v_mfma_f32_16x16x32_bf16 v[76:79], v[160:163], v[204:207], v[76:79]
    v_mov_b32 v63, s15
    ds_read_b64 v[48:49], v58 offset:0
    v_mfma_f32_16x16x32_bf16 v[80:83], v[176:179], v[192:195], v[80:83]
    ds_read_b64 v[50:51], v58 offset:1024
    ds_read_b64 v[52:53], v58 offset:2048
    v_mfma_f32_16x16x32_bf16 v[80:83], v[172:175], v[196:199], v[80:83]
    ds_read_b64 v[54:55], v58 offset:3072
    v_lshrrev_b32 v2, 2, v0
    v_mfma_f32_16x16x32_bf16 v[80:83], v[168:171], v[200:203], v[80:83]
    v_bfe_u32 v3, v0, 1, 1
    v_and_b32 v13, 1, v0
    v_mfma_f32_16x16x32_bf16 v[80:83], v[164:167], v[204:207], v[80:83]
    v_lshlrev_b32 v14, 12, v3
    v_lshl_add_u32 v14, v2, 5, v14
    v_mfma_f32_16x16x32_bf16 v[80:83], v[160:163], v[208:211], v[80:83]
    v_lshl_add_u32 v14, v13, 4, v14
    v_add_u32 v12, 49664, v14
    v_mfma_f32_16x16x32_bf16 v[84:87], v[180:183], v[192:195], v[84:87]
    v_lshlrev_b32 v2, 14, v2
    v_lshl_add_u32 v2, v3, 5, v2
    v_mfma_f32_16x16x32_bf16 v[84:87], v[176:179], v[196:199], v[84:87]
    v_lshl_add_u32 v2, v13, 4, v2
    s_lshl_b32 s14, s3, 6
    v_mfma_f32_16x16x32_bf16 v[84:87], v[172:175], v[200:203], v[84:87]
    s_add_u32 s14, s14, 2097152
    v_add_u32 v15, s14, v2
    v_mfma_f32_16x16x32_bf16 v[84:87], v[168:171], v[204:207], v[84:87]
    s_waitcnt lgkmcnt(0)
    v_dot2_f32_bf16 v32, v49, v63, 0
    v_mfma_f32_16x16x32_bf16 v[84:87], v[164:167], v[208:211], v[84:87]
    v_dot2_f32_bf16 v33, v49, v62, 0
    v_dot2_f32_bf16 v34, v48, v63, 0
    v_mfma_f32_16x16x32_bf16 v[84:87], v[160:163], v[212:215], v[84:87]
    v_dot2_f32_bf16 v35, v48, v62, 0
    v_dot2_f32_bf16 v36, v51, v63, 0
    v_mfma_f32_16x16x32_bf16 v[88:91], v[184:187], v[192:195], v[88:91]
    v_dot2_f32_bf16 v37, v51, v62, 0
    v_dot2_f32_bf16 v38, v50, v63, 0
    v_mfma_f32_16x16x32_bf16 v[88:91], v[180:183], v[196:199], v[88:91]
    v_dot2_f32_bf16 v39, v50, v62, 0
    v_dot2_f32_bf16 v40, v53, v63, 0
    v_mfma_f32_16x16x32_bf16 v[88:91], v[176:179], v[200:203], v[88:91]
    v_dot2_f32_bf16 v41, v53, v62, 0
    v_dot2_f32_bf16 v42, v52, v63, 0
    v_mfma_f32_16x16x32_bf16 v[88:91], v[172:175], v[204:207], v[88:91]
    v_dot2_f32_bf16 v43, v52, v62, 0
    v_dot2_f32_bf16 v44, v55, v63, 0
    v_mfma_f32_16x16x32_bf16 v[88:91], v[168:171], v[208:211], v[88:91]
    v_dot2_f32_bf16 v45, v55, v62, 0
    v_dot2_f32_bf16 v46, v54, v63, 0
    v_mfma_f32_16x16x32_bf16 v[88:91], v[164:167], v[212:215], v[88:91]
    v_dot2_f32_bf16 v47, v54, v62, 0
    v_mfma_f32_16x16x32_bf16 v[88:91], v[160:163], v[216:219], v[88:91]
    v_mfma_f32_16x16x32_bf16 v[92:95], v[188:191], v[192:195], v[92:95]
    v_mfma_f32_16x16x32_bf16 v[92:95], v[184:187], v[196:199], v[92:95]
    v_mfma_f32_16x16x32_bf16 v[92:95], v[180:183], v[200:203], v[92:95]
    v_mfma_f32_16x16x32_bf16 v[92:95], v[176:179], v[204:207], v[92:95]
    v_mfma_f32_16x16x32_bf16 v[92:95], v[172:175], v[208:211], v[92:95]
    v_mfma_f32_16x16x32_bf16 v[92:95], v[168:171], v[212:215], v[92:95]
    v_mfma_f32_16x16x32_bf16 v[92:95], v[164:167], v[216:219], v[92:95]
    v_mfma_f32_16x16x32_bf16 v[92:95], v[160:163], v[220:223], v[92:95]
    s_cmp_eq_u32 s55, 0
    s_cbranch_scc0 L_red1
    ds_write_b128 v56, v[68:71] offset:0
    ds_write_b128 v56, v[76:79] offset:1024
    ds_write_b128 v56, v[84:87] offset:2048
    s_nop 2
    ds_write_b128 v56, v[92:95] offset:3072
    v_pk_add_f32 v[32:33], v[32:33], v[64:65]
    v_pk_add_f32 v[34:35], v[34:35], v[66:67]
    v_pk_add_f32 v[36:37], v[36:37], v[72:73]
    v_pk_add_f32 v[38:39], v[38:39], v[74:75]
    v_pk_add_f32 v[40:41], v[40:41], v[80:81]
    v_pk_add_f32 v[42:43], v[42:43], v[82:83]
    v_pk_add_f32 v[44:45], v[44:45], v[88:89]
    v_pk_add_f32 v[46:47], v[46:47], v[90:91]
    s_branch L_convdone
L_red1:
    ds_write_b128 v56, v[64:67] offset:0
    ds_write_b128 v56, v[72:75] offset:1024
    ds_write_b128 v56, v[80:83] offset:2048
    ds_write_b128 v56, v[88:91] offset:3072
    v_pk_add_f32 v[32:33], v[32:33], v[68:69]
    v_pk_add_f32 v[34:35], v[34:35], v[70:71]
    v_pk_add_f32 v[36:37], v[36:37], v[76:77]
    v_pk_add_f32 v[38:39], v[38:39], v[78:79]
    v_pk_add_f32 v[40:41], v[40:41], v[84:85]
    v_pk_add_f32 v[42:43], v[42:43], v[86:87]
    v_pk_add_f32 v[44:45], v[44:45], v[92:93]
    v_pk_add_f32 v[46:47], v[46:47], v[94:95]
    s_branch L_convdone
L_wpref:
    s_sub_u32 s14, s4, 4
    s_lshl_b32 s15, s14, 12
    s_add_u32 s15, s15, 7348224
    v_lshl_add_u32 v2, v1, 4, s15
    v_add_u32 v3, 24576, v2
    v_add_u32 v13, 49152, v2
    v_add_u32 v14, 73728, v2
    v_lshlrev_b32 v25, 4, v1
    global_load_dwordx4 v[28:31], v25, s[32:33]
    global_load_dwordx4 v[32:35], v2, s[48:49] offset:0 sc1
    global_load_dwordx4 v[36:39], v3, s[48:49] offset:0 sc1
    global_load_dwordx4 v[40:43], v13, s[48:49] offset:0 sc1
    global_load_dwordx4 v[44:47], v14, s[48:49] offset:0 sc1
    global_load_dwordx4 v[48:51], v2, s[48:49] offset:1024 sc1
    global_load_dwordx4 v[52:55], v3, s[48:49] offset:1024 sc1
    global_load_dwordx4 v[56:59], v13, s[48:49] offset:1024 sc1
    global_load_dwordx4 v[60:63], v14, s[48:49] offset:1024 sc1
    global_load_dwordx4 v[64:67], v2, s[48:49] offset:2048 sc1
    global_load_dwordx4 v[68:71], v3, s[48:49] offset:2048 sc1
    global_load_dwordx4 v[72:75], v13, s[48:49] offset:2048 sc1
    global_load_dwordx4 v[76:79], v14, s[48:49] offset:2048 sc1
    global_load_dwordx4 v[80:83], v2, s[48:49] offset:3072 sc1
    global_load_dwordx4 v[84:87], v3, s[48:49] offset:3072 sc1
    global_load_dwordx4 v[88:91], v13, s[48:49] offset:3072 sc1
    global_load_dwordx4 v[92:95], v14, s[48:49] offset:3072 sc1
    v_lshrrev_b32 v2, 2, v0
    v_bfe_u32 v3, v0, 1, 1
    v_and_b32 v13, 1, v0
    v_lshlrev_b32 v14, 12, v3
    v_lshl_add_u32 v14, v2, 5, v14
    v_lshl_add_u32 v14, v13, 4, v14
    v_add_u32 v12, 49664, v14
    v_lshlrev_b32 v2, 14, v2
    v_lshl_add_u32 v2, v3, 5, v2
    v_lshl_add_u32 v2, v13, 4, v2
    s_lshl_b32 s14, s3, 6
    s_add_u32 s14, s14, 2097152
    v_add_u32 v15, s14, v2
L_convdone:
    s_waitcnt lgkmcnt(0)
    s_barrier
    s_cmp_ge_u32 s4, 4
    s_cbranch_scc1 L_epidone
    ds_read_b128 v[96:99], v57 offset:0
    ds_read_b128 v[100:103], v57 offset:1024
    ds_read_b128 v[104:107], v57 offset:2048
    ds_read_b128 v[108:111], v57 offset:3072
    s_waitcnt lgkmcnt(3)
    v_pk_add_f32 v[32:33], v[32:33], v[96:97]
    v_pk_add_f32 v[34:35], v[34:35], v[98:99]
    v_cvt_pk_bf16_f32 v124, v32, v33
    v_cvt_pk_bf16_f32 v125, v34, v35
    ds_write_b64 v59, v[124:125] offset:0
    s_waitcnt lgkmcnt(2)
    v_pk_add_f32 v[36:37], v[36:37], v[100:101]
    v_pk_add_f32 v[38:39], v[38:39], v[102:103]
    v_cvt_pk_bf16_f32 v126, v36, v37
    v_cvt_pk_bf16_f32 v127, v38, v39
    ds_write_b64 v59, v[126:127] offset:1024
    s_waitcnt lgkmcnt(1)
    v_pk_add_f32 v[40:41], v[40:41], v[104:105]
    v_pk_add_f32 v[42:43], v[42:43], v[106:107]
    v_cvt_pk_bf16_f32 v124, v40, v41
    v_cvt_pk_bf16_f32 v125, v42, v43
    ds_write_b64 v59, v[124:125] offset:2048
    s_waitcnt lgkmcnt(0)
    v_pk_add_f32 v[44:45], v[44:45], v[108:109]
    v_pk_add_f32 v[46:47], v[46:47], v[110:111]
    v_cvt_pk_bf16_f32 v126, v44, v45
    v_cvt_pk_bf16_f32 v127, v46, v47
    ds_write_b64 v59, v[126:127] offset:3072
L_epidone:
    s_waitcnt lgkmcnt(0)
    s_barrier
    ds_read_b128 v[8:11], v12
    s_waitcnt lgkmcnt(0)
    v_max_u32 v8, 1, v8
    v_max_u32 v9, 1, v9
    v_max_u32 v10, 1, v10
    v_max_u32 v11, 1, v11
    global_store_dwordx4 v15, v[8:11], s[48:49] sc1
    s_cmp_ge_u32 s4, 4
    s_cbranch_scc0 L_stgdone
    s_sub_u32 s14, s4, 4
    s_lshl_b32 s15, s14, 10
    s_add_u32 s15, s15, 82560
    v_lshl_add_u32 v24, v1, 2, s15
    s_mov_b32 s14, 0
    s_waitcnt vmcnt(1)
L_m3chk:
    v_mov_b32 v26, 0
    v_xor_b32 v27, s5, v34
    v_or_b32 v26, v26, v27
    v_xor_b32 v27, s5, v38
    v_or_b32 v26, v26, v27
    v_xor_b32 v27, s5, v42
    v_or_b32 v26, v26, v27
    v_xor_b32 v27, s5, v46
    v_or_b32 v26, v26, v27
    v_xor_b32 v27, s5, v50
    v_or_b32 v26, v26, v27
    v_xor_b32 v27, s5, v54
    v_or_b32 v26, v26, v27
    v_xor_b32 v27, s5, v58
    v_or_b32 v26, v26, v27
    v_xor_b32 v27, s5, v62
    v_or_b32 v26, v26, v27
    v_xor_b32 v27, s5, v66
    v_or_b32 v26, v26, v27
    v_xor_b32 v27, s5, v70
    v_or_b32 v26, v26, v27
    v_xor_b32 v27, s5, v74
    v_or_b32 v26, v26, v27
    v_xor_b32 v27, s5, v78
    v_or_b32 v26, v26, v27
    v_xor_b32 v27, s5, v82
    v_or_b32 v26, v26, v27
    v_xor_b32 v27, s5, v86
    v_or_b32 v26, v26, v27
    v_xor_b32 v27, s5, v90
    v_or_b32 v26, v26, v27
    v_xor_b32 v27, s5, v94
    v_or_b32 v26, v26, v27
    v_cmp_ne_u32 vcc, 0, v26
    s_cbranch_vccnz L_m3retry
L_m3got:
    v_pk_add_f32 v[32:33], v[32:33], v[36:37]
    v_pk_add_f32 v[40:41], v[40:41], v[44:45]
    v_pk_add_f32 v[48:49], v[48:49], v[52:53]
    v_pk_add_f32 v[56:57], v[56:57], v[60:61]
    v_pk_add_f32 v[64:65], v[64:65], v[68:69]
    v_pk_add_f32 v[72:73], v[72:73], v[76:77]
    v_pk_add_f32 v[80:81], v[80:81], v[84:85]
    v_pk_add_f32 v[88:89], v[88:89], v[92:93]
    v_pk_add_f32 v[32:33], v[32:33], v[40:41]
    v_pk_add_f32 v[48:49], v[48:49], v[56:57]
    v_pk_add_f32 v[64:65], v[64:65], v[72:73]
    v_pk_add_f32 v[80:81], v[80:81], v[88:89]
    v_cvt_pk_bf16_f32 v32, v32, v33
    ds_write_b32 v24, v32 offset:0
    v_cvt_pk_bf16_f32 v48, v48, v49
    ds_write_b32 v24, v48 offset:256
    v_cvt_pk_bf16_f32 v64, v64, v65
    ds_write_b32 v24, v64 offset:512
    v_cvt_pk_bf16_f32 v80, v80, v81
    ds_write_b32 v24, v80 offset:768
    v_lshlrev_b32 v25, 4, v1
    v_add_u32 v25, 86656, v25
    ds_write_b128 v25, v[28:31]
L_stgdone:
    s_waitcnt lgkmcnt(0)
    s_barrier
    v_lshlrev_b32 v2, 4, v1
    v_add_u32 v2, 82560, v2
    ds_read_b128 v[32:35], v2
    ds_read_b128 v[36:39], v2 offset:1024
    ds_read_b128 v[40:43], v2 offset:2048
    ds_read_b128 v[44:47], v2 offset:3072
    ds_read_b128 v[248:251], v2 offset:4096
    s_waitcnt lgkmcnt(0)
    v_and_b32 v96, 0xffff, v32
    v_and_b32 v97, 0xffff0000, v32
    v_and_b32 v98, 0xffff, v33
    v_and_b32 v99, 0xffff0000, v33
    v_and_b32 v100, 0xffff, v34
    v_and_b32 v101, 0xffff0000, v34
    v_and_b32 v102, 0xffff, v35
    v_and_b32 v103, 0xffff0000, v35
    v_lshlrev_b32 v104, 16, v36
    v_and_b32 v105, 0xffff0000, v36
    v_lshlrev_b32 v106, 16, v37
    v_and_b32 v107, 0xffff0000, v37
    v_lshlrev_b32 v108, 16, v38
    v_and_b32 v109, 0xffff0000, v38
    v_lshlrev_b32 v110, 16, v39
    v_and_b32 v111, 0xffff0000, v39
    v_lshlrev_b32 v112, 16, v40
    v_and_b32 v113, 0xffff0000, v40
    v_lshlrev_b32 v114, 16, v41
    v_and_b32 v115, 0xffff0000, v41
    v_lshlrev_b32 v116, 16, v42
    v_and_b32 v117, 0xffff0000, v42
    v_lshlrev_b32 v118, 16, v43
    v_and_b32 v119, 0xffff0000, v43
    v_lshlrev_b32 v120, 16, v44
    v_and_b32 v121, 0xffff0000, v44
    v_lshlrev_b32 v122, 16, v45
    v_and_b32 v123, 0xffff0000, v45
    v_lshlrev_b32 v124, 16, v46
    v_and_b32 v125, 0xffff0000, v46
    v_lshlrev_b32 v126, 16, v47
    v_and_b32 v127, 0xffff0000, v47
    v_add_f32 v112, 1.0, v112
    v_add_f32 v113, 1.0, v113
    v_add_f32 v114, 1.0, v114
    v_add_f32 v115, 1.0, v115
    v_add_f32 v116, 1.0, v116
    v_add_f32 v117, 1.0, v117
    v_add_f32 v118, 1.0, v118
    v_add_f32 v119, 1.0, v119
    v_cvt_pk_bf16_f32 v27, v112, v113
    v_lshlrev_b32 v112, 16, v27
    v_and_b32 v113, 0xffff0000, v27
    v_cvt_pk_bf16_f32 v27, v114, v115
    v_lshlrev_b32 v114, 16, v27
    v_and_b32 v115, 0xffff0000, v27
    v_cvt_pk_bf16_f32 v27, v116, v117
    v_lshlrev_b32 v116, 16, v27
    v_and_b32 v117, 0xffff0000, v27
    v_cvt_pk_bf16_f32 v27, v118, v119
    v_lshlrev_b32 v118, 16, v27
    v_and_b32 v119, 0xffff0000, v27
    v_lshlrev_b32 v128, 16, v248
    v_and_b32 v129, 0xffff0000, v248
    v_lshlrev_b32 v136, 16, v4
    v_and_b32 v137, 0xffff0000, v4
    v_lshlrev_b32 v130, 16, v249
    v_and_b32 v131, 0xffff0000, v249
    v_lshlrev_b32 v138, 16, v5
    v_and_b32 v139, 0xffff0000, v5
    v_lshlrev_b32 v132, 16, v250
    v_and_b32 v133, 0xffff0000, v250
    v_lshlrev_b32 v140, 16, v6
    v_and_b32 v141, 0xffff0000, v6
    v_lshlrev_b32 v134, 16, v251
    v_and_b32 v135, 0xffff0000, v251
    v_lshlrev_b32 v142, 16, v7
    v_and_b32 v143, 0xffff0000, v7
    v_mul_f32 v27, v104, v128
    v_fmac_f32 v27, v105, v129
    v_fmac_f32 v27, v106, v130
    v_fmac_f32 v27, v107, v131
    v_fmac_f32 v27, v108, v132
    v_fmac_f32 v27, v109, v133
    v_fmac_f32 v27, v110, v134
    v_fmac_f32 v27, v111, v135
    v_mul_f32 v128, v128, v112
    v_mul_f32 v129, v129, v113
    v_mul_f32 v130, v130, v114
    v_mul_f32 v131, v131, v115
    v_mul_f32 v132, v132, v116
    v_mul_f32 v133, v133, v117
    v_mul_f32 v134, v134, v118
    v_mul_f32 v135, v135, v119
    v_add_f32 v28, v128, v129
    v_add_f32 v28, v28, v130
    v_add_f32 v28, v28, v131
    v_add_f32 v28, v28, v132
    v_add_f32 v28, v28, v133
    v_add_f32 v28, v28, v134
    v_add_f32 v28, v28, v135
    v_add_f32_dpp v27, v27, v27 row_shr:1 row_mask:0xf bank_mask:0xf bound_ctrl:0
    s_nop 0
    v_add_f32_dpp v28, v28, v28 row_shr:1 row_mask:0xf bank_mask:0xf bound_ctrl:0
    v_add_f32_dpp v27, v27, v27 row_shr:2 row_mask:0xf bank_mask:0xf bound_ctrl:0
    s_nop 0
    v_add_f32_dpp v28, v28, v28 row_shr:2 row_mask:0xf bank_mask:0xf bound_ctrl:0
    v_add_f32_dpp v27, v27, v27 row_shr:4 row_mask:0xf bank_mask:0xf bound_ctrl:0
    s_nop 0
    v_add_f32_dpp v28, v28, v28 row_shr:4 row_mask:0xf bank_mask:0xf bound_ctrl:0
    v_add_f32_dpp v27, v27, v27 row_shr:8 row_mask:0xf bank_mask:0xf bound_ctrl:0
    s_nop 0
    v_add_f32_dpp v28, v28, v28 row_shr:8 row_mask:0xf bank_mask:0xf bound_ctrl:0
    v_add_f32_dpp v27, v27, v27 row_bcast:15 row_mask:0xa bank_mask:0xf
    s_nop 0
    v_add_f32_dpp v28, v28, v28 row_bcast:15 row_mask:0xa bank_mask:0xf
    v_add_f32_dpp v27, v27, v27 row_bcast:31 row_mask:0xc bank_mask:0xf
    s_nop 0
    v_add_f32_dpp v28, v28, v28 row_bcast:31 row_mask:0xc bank_mask:0xf
    v_readlane_b32 s56, v27, 63
    v_readlane_b32 s57, v28, 63
    s_lshr_b32 s14, s3, 1
    s_lshl_b32 s14, s14, 14
    s_and_b32 s15, s3, 1
    s_lshl_b32 s15, s15, 4
    s_add_u32 s14, s14, s15
    s_add_u32 s14, s14, 2097152
    v_lshl_add_u32 v2, v0, 5, s14
    v_lshlrev_b32 v3, 1, v0
    v_add_u32 v3, 71232, v3
    s_lshl_b32 s14, s3, 3
    s_add_u32 s14, s14, s4
    s_sub_u32 s58, 0xffff, s14
    s_lshl_b32 s14, s4, 2
    s_add_u32 s14, s14, 144320
    v_mov_b32 v30, s14
    v_lshlrev_b32 v31, 2, v1
    v_add_u32 v31, 144320, v31
    v_mov_b32 v29, 0x3b000000
    s_lshl_b32 s14, s3, 12
    s_add_u32 s14, s14, 4325376
    v_lshl_add_u32 v22, v1, 4, s14
    s_lshl_b32 s14, s3, 6
    s_add_u32 s14, s14, 4259840
    v_lshl_add_u32 v21, v1, 4, s14
    v_mov_b32 v23, 144320
    v_mov_b32 v34, s5
    v_mov_b32 v35, s5
    v_mov_b32 v38, s5
    v_mov_b32 v39, s5
    s_mov_b32 s14, 0
    s_waitcnt vmcnt(0)
L_e2poll:
    global_load_dwordx4 v[40:43], v2, s[48:49] sc1
    s_add_u32 s14, s14, 1
    s_waitcnt vmcnt(0)
    v_min3_u32 v36, v40, v41, v42
    v_min_u32 v36, v36, v43
    v_cmp_eq_u32 vcc, 0, v36
    s_cbranch_vccnz L_e2retry
L_e2got:
    ds_write_b16 v3, v40 offset:0
    ds_write_b16_d16_hi v3, v40 offset:1088
    ds_write_b16 v3, v41 offset:2176
    ds_write_b16_d16_hi v3, v41 offset:3264
    ds_write_b16 v3, v42 offset:4352
    ds_write_b16_d16_hi v3, v42 offset:5440
    ds_write_b16 v3, v43 offset:6528
    ds_write_b16_d16_hi v3, v43 offset:7616
    s_waitcnt lgkmcnt(0)
    s_barrier
    ds_read_b128 v[40:43], v232
    s_waitcnt lgkmcnt(0)
    v_dot2_f32_bf16 v44, v40, v96, v136
    v_dot2_f32_bf16 v45, v40, v97, v137
    v_dot2_f32_bf16 v46, v41, v98, v138
    v_dot2_f32_bf16 v47, v41, v99, v139
    v_dot2_f32_bf16 v48, v42, v100, v140
    v_dot2_f32_bf16 v49, v42, v101, v141
    v_dot2_f32_bf16 v50, v43, v102, v142
    v_dot2_f32_bf16 v51, v43, v103, v143
    v_pk_add_f32 v[24:25], v[44:45], v[46:47]
    v_pk_mul_f32 v[26:27], v[44:45], v[44:45]
    v_pk_mul_f32 v[72:73], v[44:45], v[128:129]
    v_pk_add_f32 v[24:25], v[24:25], v[48:49]
    v_pk_fma_f32 v[26:27], v[46:47], v[46:47], v[26:27]
    v_pk_fma_f32 v[72:73], v[46:47], v[130:131], v[72:73]
    v_pk_add_f32 v[24:25], v[24:25], v[50:51]
    v_pk_fma_f32 v[26:27], v[48:49], v[48:49], v[26:27]
    v_pk_fma_f32 v[72:73], v[48:49], v[132:133], v[72:73]
    v_add_f32 v24, v24, v25
    v_pk_fma_f32 v[26:27], v[50:51], v[50:51], v[26:27]
    v_pk_fma_f32 v[72:73], v[50:51], v[134:135], v[72:73]
    v_add_f32 v26, v26, v27
    v_add_f32 v72, v72, v73
    v_add_f32_dpp v24, v24, v24 row_shr:1 row_mask:0xf bank_mask:0xf bound_ctrl:0
    v_add_f32_dpp v26, v26, v26 row_shr:1 row_mask:0xf bank_mask:0xf bound_ctrl:0
    v_add_f32_dpp v72, v72, v72 row_shr:1 row_mask:0xf bank_mask:0xf bound_ctrl:0
    v_add_f32_dpp v24, v24, v24 row_shr:2 row_mask:0xf bank_mask:0xf bound_ctrl:0
    v_add_f32_dpp v26, v26, v26 row_shr:2 row_mask:0xf bank_mask:0xf bound_ctrl:0
    v_add_f32_dpp v72, v72, v72 row_shr:2 row_mask:0xf bank_mask:0xf bound_ctrl:0
    v_add_f32_dpp v24, v24, v24 row_shr:4 row_mask:0xf bank_mask:0xf bound_ctrl:0
    v_add_f32_dpp v26, v26, v26 row_shr:4 row_mask:0xf bank_mask:0xf bound_ctrl:0
    v_add_f32_dpp v72, v72, v72 row_shr:4 row_mask:0xf bank_mask:0xf bound_ctrl:0
    v_add_f32_dpp v24, v24, v24 row_shr:8 row_mask:0xf bank_mask:0xf bound_ctrl:0
    v_add_f32_dpp v26, v26, v26 row_shr:8 row_mask:0xf bank_mask:0xf bound_ctrl:0
    v_add_f32_dpp v72, v72, v72 row_shr:8 row_mask:0xf bank_mask:0xf bound_ctrl:0
    v_add_f32_dpp v24, v24, v24 row_bcast:15 row_mask:0xa bank_mask:0xf
    v_add_f32_dpp v26, v26, v26 row_bcast:15 row_mask:0xa bank_mask:0xf
    v_add_f32_dpp v72, v72, v72 row_bcast:15 row_mask:0xa bank_mask:0xf
    v_add_f32_dpp v24, v24, v24 row_bcast:31 row_mask:0xc bank_mask:0xf
    v_add_f32_dpp v26, v26, v26 row_bcast:31 row_mask:0xc bank_mask:0xf
    v_add_f32_dpp v72, v72, v72 row_bcast:31 row_mask:0xc bank_mask:0xf
    v_readlane_b32 s14, v24, 63
    v_readlane_b32 s15, v26, 63
    v_readlane_b32 s6, v72, 63
    v_mul_f32 v24, s14, v29
    v_mul_f32 v25, s15, v29
    v_mov_b32 v26, s6
    v_fma_f32 v25, -v24, v24, v25
    v_fma_f32 v26, -v24, s57, v26
    v_max_f32 v25, 0, v25
    v_add_f32 v25, 0x3727c5ac, v25
    v_rsq_f32 v25, v25
    v_mov_b32 v27, s56
    v_fmac_f32 v27, v26, v25
    v_cvt_pk_bf16_f32 v27, v27, v27
    v_and_b32 v27, 0xffff, v27
    v_xor_b32 v28, 0x8000, v27
    v_xor_b32 v32, 0xffff, v27
    v_cmp_le_u32 vcc, 0x8000, v27
    v_mul_f32 v24, v24, v25
    s_nop 0
    v_cndmask_b32 v27, v28, v32, vcc
    v_lshl_or_b32 v27, v27, 16, s58
    ds_write_b32 v30, v27
    s_waitcnt lgkmcnt(0)
    s_barrier
    s_cmp_eq_u32 s4, 7
    s_cbranch_scc0 L_nokey
    ds_read_b128 v[72:75], v23
    ds_read_b128 v[76:79], v23 offset:16
    s_waitcnt lgkmcnt(0)
    v_max_u32 v40, v72, v73
    v_min_u32 v41, v72, v73
    v_max_u32 v42, v74, v75
    v_min_u32 v43, v74, v75
    v_max_u32 v80, v76, v77
    v_min_u32 v81, v76, v77
    v_max_u32 v82, v78, v79
    v_min_u32 v83, v78, v79
    v_min_u32 v72, v40, v42
    v_max_u32 v40, v40, v42
    v_max3_u32 v41, v72, v41, v43
    v_min_u32 v72, v80, v82
    v_max_u32 v80, v80, v82
    v_max3_u32 v81, v72, v81, v83
    v_min_u32 v72, v40, v80
    v_max_u32 v40, v40, v80
    v_max3_u32 v41, v72, v41, v81
    v_mov_b32 v42, s5
    v_mov_b32 v43, s5
    s_mov_b64 s[52:53], exec
    s_mov_b64 exec, 15
    global_store_dwordx4 v21, v[40:43], s[48:49] sc1
    s_mov_b64 exec, s[52:53]
L_nokey:
    ds_read_b32 v28, v31
    v_readfirstlane_b32 s6, v27
    v_fma_f32 v56, v44, v25, -v24
    v_fma_f32 v57, v45, v25, -v24
    v_fma_f32 v58, v46, v25, -v24
    v_fma_f32 v59, v47, v25, -v24
    v_fma_f32 v60, v48, v25, -v24
    v_fma_f32 v61, v49, v25, -v24
    v_fma_f32 v62, v50, v25, -v24
    v_fma_f32 v63, v51, v25, -v24
    v_pk_fma_f32 v[56:57], v[56:57], v[112:113], v[104:105]
    v_pk_fma_f32 v[58:59], v[58:59], v[114:115], v[106:107]
    v_pk_fma_f32 v[60:61], v[60:61], v[116:117], v[108:109]
    v_pk_fma_f32 v[62:63], v[62:63], v[118:119], v[110:111]
    v_cvt_pk_bf16_f32 v64, v56, v57
    v_cvt_pk_bf16_f32 v65, v58, v59
    v_cvt_pk_bf16_f32 v66, v60, v61
    v_cvt_pk_bf16_f32 v67, v62, v63
    s_waitcnt lgkmcnt(0)
    v_cmp_lt_u32 vcc, s6, v28
    v_mov_b32 v32, v64
    v_mov_b32 v33, v65
    v_mov_b32 v36, v66
    v_mov_b32 v37, v67
    s_and_b32 s14, vcc_lo, 0xff
    s_bcnt1_i32_b32 s15, s14
    s_cmp_ge_u32 s15, 2
    s_cbranch_scc1 L_nocand
    s_lshl_b32 s14, s15, 11
    v_add_u32 v13, s14, v22
    global_store_dwordx4 v13, v[32:35], s[48:49] sc1
    global_store_dwordx4 v13, v[36:39], s[48:49] offset:1024 sc1
L_nocand:
    v_cvt_pk_bf16_f32 v52, v44, v45
    v_cvt_pk_bf16_f32 v53, v46, v47
    v_cvt_pk_bf16_f32 v54, v48, v49
    v_cvt_pk_bf16_f32 v55, v50, v51
    v_lshlrev_b32 v56, 16, v64
    v_and_b32 v57, 0xffff0000, v64
    v_lshlrev_b32 v72, 16, v52
    v_and_b32 v73, 0xffff0000, v52
    v_lshlrev_b32 v58, 16, v65
    v_and_b32 v59, 0xffff0000, v65
    v_lshlrev_b32 v74, 16, v53
    v_and_b32 v75, 0xffff0000, v53
    v_lshlrev_b32 v60, 16, v66
    v_and_b32 v61, 0xffff0000, v66
    v_lshlrev_b32 v76, 16, v54
    v_and_b32 v77, 0xffff0000, v54
    v_lshlrev_b32 v62, 16, v67
    v_and_b32 v63, 0xffff0000, v67
    v_lshlrev_b32 v78, 16, v55
    v_and_b32 v79, 0xffff0000, v55
    v_fma_f32 v56, v56, v120, v72
    v_fma_f32 v57, v57, v121, v73
    v_fma_f32 v58, v58, v122, v74
    v_fma_f32 v59, v59, v123, v75
    v_fma_f32 v60, v60, v124, v76
    v_fma_f32 v61, v61, v125, v77
    v_fma_f32 v62, v62, v126, v78
    v_fma_f32 v63, v63, v127, v79
    v_cvt_pk_bf16_f32 v68, v56, v57
    v_cvt_pk_bf16_f32 v69, v58, v59
    v_cvt_pk_bf16_f32 v70, v60, v61
    v_cvt_pk_bf16_f32 v71, v62, v63
    s_cmp_ge_u32 s4, 4
    s_cbranch_scc0 L_dmadone
    s_sub_u32 s14, s4, 4
    s_cmp_lt_u32 s93, 86
    s_cbranch_scc0 L_wp_down
    v_lshrrev_b32 v13, 1, v1
    s_lshl_b32 s15, s14, 7
    v_add_u32 v13, s15, v13
    v_mul_u32_u24 v13, 2752, v13
    v_and_b32 v14, 1, v1
    v_lshl_add_u32 v13, v14, 4, v13
    s_lshl_b32 s15, s93, 5
    v_add_u32 v13, s15, v13
    s_lshl_b32 s14, s14, 12
    s_add_u32 s14, s14, 98944
    s_add_u32 s15, s14, 0
    s_mov_b32 m0, s15
    v_mov_b32 v14, v13
    global_load_lds_dwordx4 v14, s[34:35]
    s_add_u32 s15, s14, 1024
    s_mov_b32 m0, s15
    v_add_u32 v14, 88064, v13
    global_load_lds_dwordx4 v14, s[34:35]
    s_add_u32 s15, s14, 2048
    s_mov_b32 m0, s15
    v_add_u32 v14, 176128, v13
    global_load_lds_dwordx4 v14, s[34:35]
    s_add_u32 s15, s14, 3072
    s_mov_b32 m0, s15
    v_add_u32 v14, 264192, v13
    global_load_lds_dwordx4 v14, s[34:35]
    s_add_u32 s15, s14, 16384
    s_mov_b32 m0, s15
    v_mov_b32 v14, v13
    global_load_lds_dwordx4 v14, s[36:37]
    s_add_u32 s15, s14, 17408
    s_mov_b32 m0, s15
    v_add_u32 v14, 88064, v13
    global_load_lds_dwordx4 v14, s[36:37]
    s_add_u32 s15, s14, 18432
    s_mov_b32 m0, s15
    v_add_u32 v14, 176128, v13
    global_load_lds_dwordx4 v14, s[36:37]
    s_add_u32 s15, s14, 19456
    s_mov_b32 m0, s15
    v_add_u32 v14, 264192, v13
    global_load_lds_dwordx4 v14, s[36:37]
    s_branch L_dmadone
L_wp_down:
    s_cmp_lt_u32 s94, 32
    s_cbranch_scc0 L_dmadone
    v_lshrrev_b32 v13, 1, v1
    s_lshl_b32 s52, s14, 5
    v_add_u32 v13, s52, v13
    v_lshlrev_b32 v13, 10, v13
    v_and_b32 v14, 1, v1
    v_lshl_add_u32 v13, v14, 4, v13
    s_lshl_b32 s15, s94, 5
    v_add_u32 v13, s15, v13
    s_lshl_b32 s52, s14, 10
    s_add_u32 s52, s52, 98944
    s_add_u32 s15, s52, 0
    s_mov_b32 m0, s15
    v_add_u32 v14, 0, v13
    global_load_lds_dwordx4 v14, s[38:39]
    s_add_u32 s15, s52, 4096
    s_mov_b32 m0, s15
    v_add_u32 v14, 131072, v13
    global_load_lds_dwordx4 v14, s[38:39]
    s_add_u32 s15, s52, 8192
    s_mov_b32 m0, s15
    v_add_u32 v14, 262144, v13
    global_load_lds_dwordx4 v14, s[38:39]
    s_add_u32 s15, s52, 12288
    s_mov_b32 m0, s15
    v_add_u32 v14, 393216, v13
    global_load_lds_dwordx4 v14, s[38:39]
    s_add_u32 s15, s52, 16384
    s_mov_b32 m0, s15
    v_add_u32 v14, 524288, v13
    global_load_lds_dwordx4 v14, s[38:39]
    s_add_u32 s15, s52, 20480
    s_mov_b32 m0, s15
    v_add_u32 v14, 655360, v13
    global_load_lds_dwordx4 v14, s[38:39]
    s_add_u32 s15, s52, 24576
    s_mov_b32 m0, s15
    v_add_u32 v14, 786432, v13
    global_load_lds_dwordx4 v14, s[38:39]
    s_add_u32 s15, s52, 28672
    s_mov_b32 m0, s15
    v_add_u32 v14, 917504, v13
    global_load_lds_dwordx4 v14, s[38:39]
    s_add_u32 s15, s52, 32768
    s_mov_b32 m0, s15
    v_add_u32 v14, 1048576, v13
    global_load_lds_dwordx4 v14, s[38:39]
    s_add_u32 s15, s52, 36864
    s_mov_b32 m0, s15
    v_add_u32 v14, 1179648, v13
    global_load_lds_dwordx4 v14, s[38:39]
    s_cmp_lt_u32 s14, 3
    s_cbranch_scc0 L_dmadone
    s_add_u32 s15, s52, 40960
    s_mov_b32 m0, s15
    v_add_u32 v14, 1310720, v13
    global_load_lds_dwordx4 v14, s[38:39]
L_dmadone:
    v_lshrrev_b32 v3, 4, v1
    v_bfe_u32 v2, v1, 2, 2
    v_lshl_add_u32 v2, v3, 2, v2
    v_lshlrev_b32 v2, 5, v2
    v_and_b32 v13, 3, v1
    v_lshl_add_u32 v2, v13, 3, v2
    s_lshl_b32 s14, s4, 11
    s_add_u32 s14, s14, 98944
    v_add_u32 v120, s14, v2
    v_and_b32 v13, 1, v1
    v_lshlrev_b32 v13, 10, v13
    v_lshl_add_u32 v13, v3, 3, v13
    s_lshl_b32 s14, s4, 7
    s_add_u32 s14, s14, 144512
    v_add_u32 v121, s14, v13
    v_and_b32 v13, 31, v1
    v_lshlrev_b32 v13, 5, v13
    v_add_u32 v122, 152096, v13
    s_lshl_b32 s14, s4, 2
    v_add_u32 v123, s14, v122
    s_cmp_eq_u32 s4, 0
    s_cbranch_scc0 L_t2wait
    s_cmp_lt_u32 s93, 86
    s_cbranch_scc0 L_winpoll0
    v_lshlrev_b32 v2, 6, v1
    v_add_u32 v2, 4263936, v2
    v_add_u32 v3, 8192, v2
    s_mov_b32 s14, 0
    s_waitcnt vmcnt(0)
    global_load_dwordx4 v[128:131], v2, s[48:49] offset:-4096 sc1
    global_load_dwordx4 v[132:135], v2, s[48:49] sc1
    global_load_dwordx4 v[136:139], v3, s[48:49] offset:-4096 sc1
    global_load_dwordx4 v[140:143], v3, s[48:49] sc1
    s_sleep 8
L_e3poll:
    global_load_dwordx4 v[144:147], v2, s[48:49] offset:-4096 sc1
    global_load_dwordx4 v[148:151], v2, s[48:49] sc1
    global_load_dwordx4 v[152:155], v3, s[48:49] offset:-4096 sc1
    global_load_dwordx4 v[156:159], v3, s[48:49] sc1
    s_add_u32 s14, s14, 1
    s_waitcnt vmcnt(4)
    v_xor_b32 v13, s5, v130
    v_xor_b32 v14, s5, v134
    v_xor_b32 v27, s5, v138
    v_xor_b32 v28, s5, v142
    v_or3_b32 v13, v13, v14, v27
    v_or_b32 v13, v13, v28
    v_cmp_ne_u32 vcc, 0, v13
    s_cbranch_vccz L_e3gotA
    s_cmp_ge_u32 s14, 0x40000
    s_cbranch_scc1 L_e3gotA
    global_load_dwordx4 v[128:131], v2, s[48:49] offset:-4096 sc1
    global_load_dwordx4 v[132:135], v2, s[48:49] sc1
    global_load_dwordx4 v[136:139], v3, s[48:49] offset:-4096 sc1
    global_load_dwordx4 v[140:143], v3, s[48:49] sc1
    s_waitcnt vmcnt(4)
    v_xor_b32 v13, s5, v146
    v_xor_b32 v14, s5, v150
    v_xor_b32 v27, s5, v154
    v_xor_b32 v28, s5, v158
    v_or3_b32 v13, v13, v14, v27
    v_or_b32 v13, v13, v28
    v_cmp_ne_u32 vcc, 0, v13
    s_cbranch_vccnz L_e3poll
    v_min_u32 v13, v144, v148
    v_max_u32 v32, v144, v148
    v_max3_u32 v33, v13, v145, v149
    v_min_u32 v13, v32, v152
    v_max_u32 v32, v32, v152
    v_max3_u32 v33, v13, v33, v153
    v_min_u32 v13, v32, v156
    v_max_u32 v32, v32, v156
    v_max3_u32 v33, v13, v33, v157
    s_branch L_e3got
L_e3gotA:
    v_min_u32 v13, v128, v132
    v_max_u32 v32, v128, v132
    v_max3_u32 v33, v13, v129, v133
    v_min_u32 v13, v32, v136
    v_max_u32 v32, v32, v136
    v_max3_u32 v33, v13, v33, v137
    v_min_u32 v13, v32, v140
    v_max_u32 v32, v32, v140
    v_max3_u32 v33, v13, v33, v141
L_e3got:
    s_nop 0
    v_mov_b32_dpp v36, v32 row_shr:1 row_mask:0xf bank_mask:0xf bound_ctrl:0
    v_mov_b32_dpp v37, v33 row_shr:1 row_mask:0xf bank_mask:0xf bound_ctrl:0
    v_min_u32 v13, v32, v36
    v_max_u32 v32, v32, v36
    v_max3_u32 v33, v13, v33, v37
    s_nop 0
    v_mov_b32_dpp v36, v32 row_shr:2 row_mask:0xf bank_mask:0xf bound_ctrl:0
    v_mov_b32_dpp v37, v33 row_shr:2 row_mask:0xf bank_mask:0xf bound_ctrl:0
    v_min_u32 v13, v32, v36
    v_max_u32 v32, v32, v36
    v_max3_u32 v33, v13, v33, v37
    s_nop 0
    v_mov_b32_dpp v36, v32 row_shr:4 row_mask:0xf bank_mask:0xf bound_ctrl:0
    v_mov_b32_dpp v37, v33 row_shr:4 row_mask:0xf bank_mask:0xf bound_ctrl:0
    v_min_u32 v13, v32, v36
    v_max_u32 v32, v32, v36
    v_max3_u32 v33, v13, v33, v37
    s_nop 0
    v_mov_b32_dpp v36, v32 row_shr:8 row_mask:0xf bank_mask:0xf bound_ctrl:0
    v_mov_b32_dpp v37, v33 row_shr:8 row_mask:0xf bank_mask:0xf bound_ctrl:0
    v_min_u32 v13, v32, v36
    v_max_u32 v32, v32, v36
    v_max3_u32 v33, v13, v33, v37
    v_mov_b32 v36, 0
    v_mov_b32 v37, 0
    s_nop 0
    v_mov_b32_dpp v36, v32 row_bcast:15 row_mask:0xa bank_mask:0xf
    v_mov_b32_dpp v37, v33 row_bcast:15 row_mask:0xa bank_mask:0xf
    v_min_u32 v13, v32, v36
    v_max_u32 v32, v32, v36
    v_max3_u32 v33, v13, v33, v37
    v_mov_b32 v36, 0
    v_mov_b32 v37, 0
    s_nop 0
    v_mov_b32_dpp v36, v32 row_bcast:31 row_mask:0xc bank_mask:0xf
    v_mov_b32_dpp v37, v33 row_bcast:31 row_mask:0xc bank_mask:0xf
    v_min_u32 v13, v32, v36
    v_max_u32 v32, v32, v36
    v_max3_u32 v33, v13, v33, v37
    v_readlane_b32 s58, v32, 63
    v_readlane_b32 s59, v33, 63
    v_lshlrev_b32 v13, 4, v1
    v_add_u32 v13, 4325376, v13
    s_nop 0
    s_and_b32 s50, s58, 0xffff
    s_sub_u32 s50, 0xffff, s50
    s_and_b32 s51, s59, 0xffff
    s_sub_u32 s51, 0xffff, s51
    s_lshr_b32 s52, s50, 3
    s_lshr_b32 s53, s51, 3
    s_cmp_eq_u32 s52, s53
    s_cselect_b32 s14, 1, 0
    s_lshl_b32 s52, s52, 12
    s_lshl_b32 s53, s53, 1
    s_add_u32 s53, s53, s14
    s_lshl_b32 s53, s53, 11
    v_add_u32 v2, s52, v13
    v_add_u32 v3, s53, v13
    s_mov_b32 s14, 0
    global_load_dwordx4 v[36:39], v2, s[48:49] sc1
    global_load_dwordx4 v[40:43], v2, s[48:49] offset:1024 sc1
    global_load_dwordx4 v[44:47], v3, s[48:49] sc1
    global_load_dwordx4 v[48:51], v3, s[48:49] offset:1024 sc1
    v_mov_b32 v27, 144384
    v_mov_b32 v32, s58
    v_mov_b32 v33, s59
    ds_write_b64 v27, v[32:33]
    s_cmp_eq_u32 s93, 0
    s_cbranch_scc0 L_nowin
    s_mov_b64 s[6:7], exec
    s_mov_b64 exec, 15
    v_lshlrev_b32 v27, 4, v1
    v_add_u32 v27, 6488064, v27
    v_mov_b32 v34, s5
    v_mov_b32 v35, s5
    global_store_dwordx4 v27, v[32:35], s[48:49] sc1
    s_mov_b64 exec, s[6:7]
    s_waitcnt vmcnt(1)
    s_branch L_rowchk
L_nowin:
    s_waitcnt vmcnt(0)
L_rowchk:
    v_lshlrev_b32 v27, 4, v1
    v_add_u32 v27, 144512, v27
    v_xor_b32 v13, s5, v38
    v_xor_b32 v14, s5, v42
    v_xor_b32 v28, s5, v46
    v_xor_b32 v52, s5, v50
    v_or3_b32 v13, v13, v14, v28
    v_or_b32 v13, v13, v52
    v_cmp_ne_u32 vcc, 0, v13
    s_cbranch_vccnz L_rowretry
L_rowgot:
    ds_write_b64 v27, v[36:37]
    ds_write_b64 v27, v[40:41] offset:8
    ds_write_b64 v27, v[44:45] offset:1024
    ds_write_b64 v27, v[48:49] offset:1032
L_t2wait:
    s_waitcnt vmcnt(0) lgkmcnt(0)
    s_barrier
    v_mov_b32 v27, 144384
    ds_read_b64 v[32:33], v27
    s_cmp_lt_u32 s93, 86
    s_cbranch_scc0 L_notgu
    ds_read_b64 v[36:37], v121 offset:0
    ds_read_b64 v[38:39], v121 offset:32
    ds_read_b64_tr_b16 v[44:45], v120 offset:0
    ds_read_b64_tr_b16 v[46:47], v120 offset:512
    ds_read_b64_tr_b16 v[60:61], v120 offset:16384
    ds_read_b64_tr_b16 v[62:63], v120 offset:16896
    ds_read_b64 v[40:41], v121 offset:64
    ds_read_b64 v[42:43], v121 offset:96
    ds_read_b64_tr_b16 v[48:49], v120 offset:1024
    ds_read_b64_tr_b16 v[50:51], v120 offset:1536
    ds_read_b64_tr_b16 v[64:65], v120 offset:17408
    ds_read_b64_tr_b16 v[66:67], v120 offset:17920
    v_cmp_gt_u32 vcc, 16, v1
    s_waitcnt lgkmcnt(0)
    v_mfma_f32_16x16x32_bf16 v[72:75], v[36:39], v[44:47], 0
    v_mfma_f32_16x16x32_bf16 v[76:79], v[36:39], v[60:63], 0
    v_mfma_f32_16x16x32_bf16 v[72:75], v[40:43], v[48:51], v[72:75]
    v_mfma_f32_16x16x32_bf16 v[76:79], v[40:43], v[64:67], v[76:79]
    v_readfirstlane_b32 s58, v32
    v_readfirstlane_b32 s59, v33
    s_and_saveexec_b64 s[6:7], vcc
    s_nop 3
    ds_write_b32 v123, v72
    ds_write_b32 v123, v73 offset:512
    ds_write_b32 v123, v76 offset:1024
    ds_write_b32 v123, v77 offset:1536
    s_mov_b64 exec, s[6:7]
    s_waitcnt lgkmcnt(0)
    s_barrier
    s_cmp_eq_u32 s4, 0
    s_cbranch_scc0 L_gudone
    ds_read_b128 v[44:47], v122
    ds_read_b128 v[48:51], v122 offset:16
    ds_read_b128 v[52:55], v122 offset:1024
    ds_read_b128 v[56:59], v122 offset:1040
    v_lshlrev_b32 v13, 4, v1
    s_lshl_b32 s14, s93, 7
    s_add_u32 s14, s14, 6422528
    v_add_u32 v14, s14, v13
    v_mov_b32 v38, s5
    v_mov_b32 v39, s5
    s_waitcnt lgkmcnt(0)
    v_pk_add_f32 v[44:45], v[44:45], v[48:49]
    v_pk_add_f32 v[52:53], v[52:53], v[56:57]
    v_pk_add_f32 v[46:47], v[46:47], v[50:51]
    v_pk_add_f32 v[54:55], v[54:55], v[58:59]
    v_pk_add_f32 v[44:45], v[44:45], v[46:47]
    v_pk_add_f32 v[52:53], v[52:53], v[54:55]
    v_add_f32 v36, v44, v45
    v_add_f32 v40, v52, v53
    v_cvt_pk_bf16_f32 v36, v36, v40
    v_and_b32 v40, 0xffff0000, v36
    v_lshlrev_b32 v36, 16, v36
    v_mul_f32 v2, 0xbfb8aa3b, v36
    v_exp_f32 v2, v2
    s_nop 0
    v_add_f32 v2, 1.0, v2
    v_rcp_f32 v2, v2
    s_nop 0
    v_mul_f32 v2, v2, v36
    v_cvt_pk_bf16_f32 v2, v2, v2
    v_lshlrev_b32 v2, 16, v2
    v_mul_f32 v2, v2, v40
    v_cvt_pk_bf16_f32 v2, v2, v2
    s_mov_b32 s14, 0x05040100
    v_mov_b32_dpp v3, v2 quad_perm:[1,1,3,3] row_mask:0xf bank_mask:0xf
    v_perm_b32 v2, v3, v2, s14
    s_nop 0
    v_mov_b32_dpp v3, v2 quad_perm:[2,2,2,2] row_mask:0xf bank_mask:0xf
    ds_bpermute_b32 v36, v13, v2
    ds_bpermute_b32 v37, v13, v3
    s_mov_b64 s[6:7], exec
    s_mov_b64 exec, 0xff
    s_waitcnt lgkmcnt(0)
    global_store_dwordx4 v14, v[36:39], s[48:49] sc1
    s_mov_b64 exec, s[6:7]
L_gudone:
    s_and_b32 s50, s58, 0xffff
    s_sub_u32 s50, 0xffff, s50
    s_and_b32 s51, s59, 0xffff
    s_sub_u32 s51, 0xffff, s51
    s_lshr_b32 s52, s50, 3
    s_lshr_b32 s53, s51, 3
    s_cmp_eq_u32 s52, s53
    s_cselect_b32 s14, 1, 0
    s_lshl_b32 s52, s52, 12
    s_lshl_b32 s53, s53, 1
    s_add_u32 s53, s53, s14
    s_lshl_b32 s53, s53, 11
    s_branch L_outrows
L_notgu:
    s_waitcnt lgkmcnt(0)
    v_readfirstlane_b32 s58, v32
    v_readfirstlane_b32 s59, v33
    s_nop 2
    s_and_b32 s50, s58, 0xffff
    s_sub_u32 s50, 0xffff, s50
    s_and_b32 s51, s59, 0xffff
    s_sub_u32 s51, 0xffff, s51
    s_lshr_b32 s52, s50, 3
    s_lshr_b32 s53, s51, 3
    s_cmp_eq_u32 s52, s53
    s_cselect_b32 s14, 1, 0
    s_lshl_b32 s52, s52, 12
    s_lshl_b32 s53, s53, 1
    s_add_u32 s53, s53, s14
    s_lshl_b32 s53, s53, 11
L_outrows:
    s_lshl_b32 s14, s3, 3
    s_add_u32 s14, s14, s4
    s_cmp_eq_u32 s14, s50
    s_cbranch_scc1 L_skipout
    s_cmp_eq_u32 s14, s51
    s_cbranch_scc1 L_skipout
    s_lshl_b32 s14, s14, 10
    v_lshl_add_u32 v2, v1, 4, s14
    global_store_dwordx4 v2, v[68:71], s[44:45] sc1
L_skipout:
    s_cmp_lt_u32 s94, 32
    s_cbranch_scc0 L_fin
    s_lshl_b32 s56, s94, 4
    v_and_b32 v13, 15, v1
    v_bfe_u32 v14, v1, 4, 1
    v_add_u32 v55, s56, v13
    v_cmp_eq_u32 vcc, 1, v14
    v_mov_b32 v27, s52
    v_mov_b32 v28, s53
    v_cndmask_b32 v27, v27, v28, vcc
    v_lshrrev_b32 v28, 3, v55
    v_bfe_u32 v29, v55, 2, 1
    v_lshlrev_b32 v29, 10, v29
    v_lshl_add_u32 v28, v28, 4, v29
    v_add_u32 v27, v27, v28
    v_add_u32 v27, 4325376, v27
    v_mov_b32 v60, s50
    v_mov_b32 v52, s51
    v_cndmask_b32 v60, v60, v52, vcc
    v_lshrrev_b32 v28, 4, v60
    v_lshlrev_b32 v28, 14, v28
    v_lshl_add_u32 v28, v55, 5, v28
    v_and_b32 v29, 15, v60
    v_lshl_add_u32 v28, v29, 1, v28
    v_add_u32 v28, 2097152, v28
    v_lshlrev_b32 v60, 10, v60
    v_lshl_add_u32 v60, v55, 1, v60
    v_lshlrev_b32 v29, 1, v55
    v_add_u32 v29, 82560, v29
    global_load_dwordx4 v[40:43], v27, s[48:49] sc1
    global_load_ushort v44, v28, s[48:49] sc1
    global_load_ushort v45, v60, s[16:17]
    ds_read_u16 v46, v29
    ds_read_u16 v48, v29 offset:3072
    v_lshlrev_b32 v2, 4, v0
    v_add_u32 v2, 6422528, v2
    v_min_u32 v3, 175, v0
    v_lshlrev_b32 v3, 4, v3
    v_add_u32 v3, 6430720, v3
    v_bfe_u32 v30, v0, 2, 1
    v_mul_u32_u24 v30, 2768, v30
    v_lshrrev_b32 v31, 3, v0
    v_lshl_add_u32 v30, v31, 5, v30
    v_and_b32 v31, 3, v0
    v_lshl_add_u32 v30, v31, 3, v30
    v_add_u32 v30, 146560, v30
    v_min_u32 v56, 175, v0
    v_bfe_u32 v57, v56, 2, 1
    v_mul_u32_u24 v57, 2768, v57
    v_lshrrev_b32 v31, 3, v56
    v_lshl_add_u32 v57, v31, 5, v57
    v_and_b32 v31, 3, v56
    v_lshl_add_u32 v57, v31, 3, v57
    v_add_u32 v57, 148608, v57
    v_lshrrev_b32 v3, 4, v1
    v_bfe_u32 v58, v1, 2, 2
    v_lshl_add_u32 v58, v3, 2, v58
    v_lshlrev_b32 v58, 5, v58
    v_and_b32 v13, 3, v1
    v_lshl_add_u32 v58, v13, 3, v58
    s_lshl_b32 s14, s4, 10
    s_add_u32 s14, s14, 98944
    v_add_u32 v58, s14, v58
    v_and_b32 v59, 1, v1
    v_mul_u32_u24 v59, 2768, v59
    v_lshrrev_b32 v31, 4, v1
    v_lshl_add_u32 v59, v31, 3, v59
    s_lshl_b32 s14, s4, 6
    s_add_u32 s14, s14, 146560
    v_add_u32 v59, s14, v59
    v_min_u32 v3, 175, v0
    v_lshlrev_b32 v3, 4, v3
    v_add_u32 v3, 6430720, v3
    s_mov_b32 s14, 0
L_rxpoll:
    s_waitcnt vmcnt(0) lgkmcnt(0)
    v_cmp_ne_u32 vcc, s5, v42
    s_cbranch_vccnz L_rxretry
L_rxgot:
    v_and_b32 v31, 3, v55
    v_cmp_le_u32 vcc, 2, v31
    s_nop 1
    v_cndmask_b32 v40, v40, v41, vcc
    v_and_b32 v31, 1, v55
    v_cmp_eq_u32 vcc, 1, v31
    v_lshlrev_b32 v50, 16, v40
    v_and_b32 v40, 0xffff0000, v40
    v_cndmask_b32 v40, v50, v40, vcc
    v_lshlrev_b32 v46, 16, v46
    v_lshlrev_b32 v48, 16, v48
    v_lshlrev_b32 v44, 16, v44
    v_lshlrev_b32 v45, 16, v45
    v_mul_f32 v44, v44, v46
    v_cvt_pk_bf16_f32 v44, v44, v44
    v_lshlrev_b32 v44, 16, v44
    v_add_f32 v44, v44, v45
    v_cvt_pk_bf16_f32 v44, v44, v44
    v_lshlrev_b32 v44, 16, v44
    v_bfe_u32 v14, v1, 4, 1
    v_cmp_eq_u32 vcc, 1, v14
    v_mov_b32 v50, s58
    v_mov_b32 v51, s59
    v_cndmask_b32 v50, v50, v51, vcc
    v_lshrrev_b32 v50, 16, v50
    v_xor_b32 v51, 0x8000, v50
    v_xor_b32 v52, 0xffff, v50
    s_mov_b32 s14, 0x8000
    v_cmp_le_u32 s[6:7], s14, v50
    s_nop 1
    v_cndmask_b32 v50, v52, v51, s[6:7]
    v_lshlrev_b32 v50, 16, v50
    v_mul_f32 v50, 0xbfb8aa3b, v50
    v_exp_f32 v50, v50
    s_nop 0
    v_add_f32 v50, 1.0, v50
    v_rcp_f32 v50, v50
    s_nop 0
    v_cvt_pk_bf16_f32 v50, v50, v50
    v_lshlrev_b32 v50, 16, v50
    s_mov_b32 s14, 0
    ds_read_b64_tr_b16 v[96:97], v58 offset:0
    ds_read_b64_tr_b16 v[98:99], v58 offset:512
    ds_read_b64_tr_b16 v[100:101], v58 offset:8192
    ds_read_b64_tr_b16 v[102:103], v58 offset:8704
    ds_read_b64_tr_b16 v[104:105], v58 offset:16384
    ds_read_b64_tr_b16 v[106:107], v58 offset:16896
    ds_read_b64_tr_b16 v[108:109], v58 offset:24576
    ds_read_b64_tr_b16 v[110:111], v58 offset:25088
    ds_read_b64_tr_b16 v[112:113], v58 offset:32768
    ds_read_b64_tr_b16 v[114:115], v58 offset:33280
    s_cmp_lt_u32 s4, 3
    s_cbranch_scc0 L_dnw5
    ds_read_b64_tr_b16 v[116:117], v58 offset:40960
    ds_read_b64_tr_b16 v[118:119], v58 offset:41472
L_dnw5:
    global_load_dwordx4 v[128:131], v2, s[48:49] sc1
    global_load_dwordx4 v[132:135], v3, s[48:49] sc1
    s_sleep 8
L_e4poll:
    global_load_dwordx4 v[144:147], v2, s[48:49] sc1
    global_load_dwordx4 v[148:151], v3, s[48:49] sc1
    s_add_u32 s14, s14, 1
    s_waitcnt vmcnt(2)
    v_xor_b32 v52, s5, v130
    v_xor_b32 v53, s5, v134
    v_or_b32 v52, v52, v53
    v_cmp_ne_u32 vcc, 0, v52
    s_cbranch_vccz L_e4gotA
    s_cmp_ge_u32 s14, 0x40000
    s_cbranch_scc1 L_e4gotA
    global_load_dwordx4 v[128:131], v2, s[48:49] sc1
    global_load_dwordx4 v[132:135], v3, s[48:49] sc1
    s_waitcnt vmcnt(2)
    v_xor_b32 v52, s5, v146
    v_xor_b32 v53, s5, v150
    v_or_b32 v52, v52, v53
    v_cmp_ne_u32 vcc, 0, v52
    s_cbranch_vccnz L_e4poll
    ds_write_b64 v30, v[144:145]
    ds_write_b64 v57, v[148:149]
    s_branch L_e4got
L_e4gotA:
    ds_write_b64 v30, v[128:129]
    ds_write_b64 v57, v[132:133]
L_e4got:
    s_waitcnt lgkmcnt(0)
    s_barrier
    ds_read_b64 v[64:65], v59 offset:0
    ds_read_b64 v[66:67], v59 offset:32
    ds_read_b64 v[68:69], v59 offset:512
    ds_read_b64 v[70:71], v59 offset:544
    ds_read_b64 v[72:73], v59 offset:1024
    ds_read_b64 v[74:75], v59 offset:1056
    ds_read_b64 v[76:77], v59 offset:1536
    ds_read_b64 v[78:79], v59 offset:1568
    ds_read_b64 v[80:81], v59 offset:2048
    ds_read_b64 v[82:83], v59 offset:2080
    s_cmp_lt_u32 s4, 3
    s_cbranch_scc0 L_dn5
    ds_read_b64 v[84:85], v59 offset:2560
    ds_read_b64 v[86:87], v59 offset:2592
    s_waitcnt lgkmcnt(0)
    v_mfma_f32_16x16x32_bf16 v[92:95], v[84:87], v[116:119], 0
    s_branch L_dn6
L_dn5:
    s_nop 6
    v_mov_b64 v[92:93], 0
    v_mov_b64 v[94:95], 0
    s_waitcnt lgkmcnt(0)
L_dn6:
    v_mfma_f32_16x16x32_bf16 v[88:91], v[64:67], v[96:99], 0
    v_mfma_f32_16x16x32_bf16 v[92:95], v[68:71], v[100:103], v[92:95]
    v_mfma_f32_16x16x32_bf16 v[88:91], v[72:75], v[104:107], v[88:91]
    v_mfma_f32_16x16x32_bf16 v[92:95], v[76:79], v[108:111], v[92:95]
    v_mfma_f32_16x16x32_bf16 v[88:91], v[80:83], v[112:115], v[88:91]
    v_cmp_gt_u32 vcc, 16, v1
    s_nop 5
    s_nop 0
    v_pk_add_f32 v[92:93], v[92:93], v[88:89]
    s_and_saveexec_b64 s[6:7], vcc
    ds_write_b32 v123, v92
    ds_write_b32 v123, v93 offset:512
    s_mov_b64 exec, s[6:7]
    s_waitcnt lgkmcnt(0)
    s_barrier
    s_cmp_eq_u32 s4, 0
    s_cbranch_scc0 L_fin
    ds_read_b128 v[64:67], v122
    ds_read_b128 v[68:71], v122 offset:16
    v_cmp_gt_u32 vcc, 32, v1
    s_waitcnt lgkmcnt(0)
    v_pk_add_f32 v[64:65], v[64:65], v[68:69]
    v_pk_add_f32 v[66:67], v[66:67], v[70:71]
    v_pk_add_f32 v[64:65], v[64:65], v[66:67]
    v_add_f32 v64, v64, v65
    v_cvt_pk_bf16_f32 v64, v64, v64
    v_and_b32 v64, 0xffff0000, v64
    v_fma_f32 v64, v64, v50, v40
    v_fma_f32 v64, v64, v48, v44
    v_cvt_pk_bf16_f32 v64, v64, v64
    s_and_saveexec_b64 s[6:7], vcc
    global_store_short v60, v64, s[44:45]
    s_mov_b64 exec, s[6:7]
L_fin:
L_end:
    s_endpgm
L_npoll:
    v_mov_b32 v14, 0
    global_load_dword v15, v14, s[46:47] sc1
    s_add_u32 s14, s14, 1
    s_waitcnt vmcnt(0)
    v_readfirstlane_b32 s15, v15
    s_cmp_ge_u32 s14, 0x40000
    s_cbranch_scc1 L_ngot
    s_nop 1
    s_cmp_lg_u32 s15, 0
    s_cbranch_scc1 L_ngot
    s_branch L_npoll
L_e1retry:
    s_cmp_ge_u32 s14, 0x40000
    s_cbranch_scc1 L_e1got
    s_branch L_e1poll
L_m3retry:
    s_add_u32 s14, s14, 1
    s_cmp_ge_u32 s14, 0x40000
    s_cbranch_scc1 L_m3got
    s_sub_u32 s15, s4, 4
    s_lshl_b32 s15, s15, 12
    s_add_u32 s15, s15, 7348224
    v_lshl_add_u32 v2, v1, 4, s15
    v_add_u32 v3, 24576, v2
    v_add_u32 v13, 49152, v2
    v_add_u32 v14, 73728, v2
    global_load_dwordx4 v[32:35], v2, s[48:49] offset:0 sc1
    global_load_dwordx4 v[36:39], v3, s[48:49] offset:0 sc1
    global_load_dwordx4 v[40:43], v13, s[48:49] offset:0 sc1
    global_load_dwordx4 v[44:47], v14, s[48:49] offset:0 sc1
    global_load_dwordx4 v[48:51], v2, s[48:49] offset:1024 sc1
    global_load_dwordx4 v[52:55], v3, s[48:49] offset:1024 sc1
    global_load_dwordx4 v[56:59], v13, s[48:49] offset:1024 sc1
    global_load_dwordx4 v[60:63], v14, s[48:49] offset:1024 sc1
    global_load_dwordx4 v[64:67], v2, s[48:49] offset:2048 sc1
    global_load_dwordx4 v[68:71], v3, s[48:49] offset:2048 sc1
    global_load_dwordx4 v[72:75], v13, s[48:49] offset:2048 sc1
    global_load_dwordx4 v[76:79], v14, s[48:49] offset:2048 sc1
    global_load_dwordx4 v[80:83], v2, s[48:49] offset:3072 sc1
    global_load_dwordx4 v[84:87], v3, s[48:49] offset:3072 sc1
    global_load_dwordx4 v[88:91], v13, s[48:49] offset:3072 sc1
    global_load_dwordx4 v[92:95], v14, s[48:49] offset:3072 sc1
    s_waitcnt vmcnt(0)
    s_branch L_m3chk
L_e2retry:
    s_cmp_ge_u32 s14, 0x40000
    s_cbranch_scc1 L_e2got
    s_branch L_e2poll
L_rowretry:
    s_add_u32 s14, s14, 1
    s_cmp_ge_u32 s14, 0x40000
    s_cbranch_scc1 L_rowgot
    global_load_dwordx4 v[36:39], v2, s[48:49] sc1
    global_load_dwordx4 v[40:43], v2, s[48:49] offset:1024 sc1
    global_load_dwordx4 v[44:47], v3, s[48:49] sc1
    global_load_dwordx4 v[48:51], v3, s[48:49] offset:1024 sc1
    s_waitcnt vmcnt(0)
    s_branch L_rowchk
L_winpoll0:
    v_mov_b32 v2, 6488064
    s_mov_b32 s14, 0
L_winpoll:
    global_load_dwordx4 v[32:35], v2, s[48:49] sc1
    s_add_u32 s14, s14, 1
    s_waitcnt vmcnt(0)
    v_readfirstlane_b32 s15, v34
    s_nop 3
    s_cmp_eq_u32 s15, s5
    s_cbranch_scc1 L_wingot
    s_cmp_ge_u32 s14, 0x40000
    s_cbranch_scc1 L_wingot
    s_sleep 6
    s_branch L_winpoll
L_wingot:
    v_mov_b32 v2, 144384
    ds_write_b64 v2, v[32:33]
    s_branch L_t2wait
L_rxretry:
    s_add_u32 s14, s14, 1
    s_cmp_ge_u32 s14, 0x40000
    s_cbranch_scc1 L_rxgot
    global_load_dwordx4 v[40:43], v27, s[48:49] sc1
    s_branch L_rxpoll
.fill 256, 4, 0xbf800000
.section .rodata,"a"
.p2align 6
.amdhsa_kernel adaLN_cond__ssm_conv_s4d__moe_arch_mod__prompt_kernel
  .amdhsa_next_free_vgpr 256
  .amdhsa_next_free_sgpr 96
  .amdhsa_accum_offset 256
  .amdhsa_group_segment_fixed_size 0
  .amdhsa_kernarg_size 136
  .amdhsa_user_sgpr_count 2
  .amdhsa_user_sgpr_kernarg_segment_ptr 1
  .amdhsa_system_sgpr_workgroup_id_x 1
.end_amdhsa_kernel
```
